```python
import torch

def _softmax(x, axis=-1):
    return torch.softmax(x, dim=axis)
def _gelu(x):
    return torch.nn.functional.gelu(x, approximate="tanh")
def _silu(x):
    return torch.nn.functional.silu(x)
def _sigmoid(x):
    return torch.sigmoid(x)
def _layernorm(x, axis=-1, eps=1e-5):
    m = x.mean(dim=axis, keepdim=True)
    v = x.var(dim=axis, keepdim=True, unbiased=False)
    return (x - m) / torch.sqrt(v + eps)
def _scatter_add(tgt, idx, src, axis=0):
    return tgt.clone().index_add_(axis, idx, src)
def _segment_sum(src, seg, n):
    out = torch.zeros((n,) + src.shape[1:], dtype=src.dtype)
    return out.index_add_(0, seg, src)
def _pad(x, pw):
    flat = tuple(v for pair in reversed(pw) for v in pair)
    return torch.nn.functional.pad(x, flat)

kernel_name = 'standalone__paged_block_table_kv_radixattention__sampling'

def setup_inputs():

    _w = (lambda a: (lambda t: t.to(torch.bfloat16) if t.is_floating_point() else t)(torch.as_tensor(a)))
    B, H, Hkv, Dh = 8, 32, 8, 128
    Lk = 8192
    bs = 16
    nb = max(2, Lk // bs)
    P = max(1, nb // 2)
    n_phys = P + B * (nb - P)
    shared = torch.arange(P, dtype=torch.int64)
    priv = P + torch.arange(B * (nb - P), dtype=torch.int64).reshape(B, nb - P)
    bt = torch.cat([torch.tile(shared[None, :], (B, 1)), priv], dim=1)
    ctx = nb * bs - (torch.arange(1, B + 1, dtype=torch.int64) * 2654435761) % max(1, (nb * bs - P * bs) // 2)
    return {
        "q": _w((lambda *s: torch.randn(*s, dtype=torch.bfloat16) * 0.8)(B, H, Dh)),
        "k_cache": _w((lambda *s: torch.randn(*s, dtype=torch.bfloat16) * 0.8)(n_phys, bs, Hkv, Dh)),
        "v_cache": _w((lambda *s: torch.randn(*s, dtype=torch.bfloat16) * 0.05)(n_phys, bs, Hkv, Dh)),
        "block_table": _w(bt.to(torch.int64)),
        "ctx_lens": _w(torch.as_tensor(ctx).to(torch.int64)),
    }

def reference(q, k_cache, v_cache, block_table, ctx_lens):
    B, H, Dh = q.shape
    n_phys, bs, Hkv, _ = k_cache.shape
    nb = block_table.shape[1]
    Lk = nb * bs
    rep = H // Hkv
    k = k_cache[block_table].reshape(B, Lk, Hkv, Dh)
    v = v_cache[block_table].reshape(B, Lk, Hkv, Dh)
    k = (lambda x, n, axis: torch.repeat_interleave(x, n, dim=axis))(k, rep, axis=2)
    v = (lambda x, n, axis: torch.repeat_interleave(x, n, dim=axis))(v, rep, axis=2)
    scores = torch.einsum("bhd,bkhd->bhk", q, k) * (Dh ** -0.5)
    pos = torch.arange(Lk)
    valid = pos[None, :] < ctx_lens[:, None]
    scores = torch.where(valid[:, None, :], scores, -1e9)
    p = _softmax(scores, axis=-1)
    return torch.einsum("bhk,bkhd->bhd", p, v)
```

```asm
; @launch grid=(256,1,1) block=(512,1,1) lds=141568
.amdgcn_target "amdgcn-amd-amdhsa--gfx950"
.text
.globl standalone__paged_block_table_kv_radixattention__sampling_kernel
.p2align 8
.type standalone__paged_block_table_kv_radixattention__sampling_kernel,@function
standalone__paged_block_table_kv_radixattention__sampling_kernel:
    s_cmp_ge_u32 s2, 256
    s_cbranch_scc1 L_exit
    s_load_dwordx16 s[4:19], s[0:1], 0
    s_memrealtime s[92:93]
    s_getpc_b64 s[20:21]
L_pc:
    s_sub_u32 s20, s20, L_pc - standalone__paged_block_table_kv_radixattention__sampling_kernel
    s_subb_u32 s21, s21, 0
    v_lshlrev_b32 v21, 4, v0
    global_load_dwordx4 v[244:247], v21, s[20:21]
    v_add_u32 v21, 0x2000, v21
    v_min_u32 v22, L_code_end - standalone__paged_block_table_kv_radixattention__sampling_kernel - 16, v21
    global_load_dwordx4 v[244:247], v22, s[20:21]
    v_lshrrev_b32 v21, 6, v0
    v_and_b32 v1, 63, v0
    v_readfirstlane_b32 s73, v21
    s_and_b32 s74, s2, 3
    s_lshr_b32 s75, s2, 2
    v_mov_b32 v6, 0
    v_mov_b32 v232, 0
    v_lshrrev_b32 v227, 4, v1
    v_bfe_u32 v228, v1, 2, 2
    v_and_b32 v229, 3, v1
    s_and_b32 s76, s73, 1
    s_lshr_b32 s77, s73, 1
    s_lshl_b32 s101, s74, 1
    s_add_u32 s101, s101, s76
    s_lshl_b32 s94, s101, 8
    v_lshl_add_u32 v2, v229, 4, s94
    v_lshl_add_u32 v2, v227, 6, v2
    v_lshl_add_u32 v2, v228, 13, v2
    v_add_u32 v3, 0x1000, v2
    s_mov_b32 s22, 0x4800000
    s_mov_b32 s23, 0x20000
    s_sub_i32 s90, s75, 13
    s_sub_i32 s96, s90, 24
    s_mov_b32 s95, 2024335
    s_mov_b32 s97, 49414144
    s_cmp_lt_i32 s90, 24
    s_cselect_b32 s96, s90, s96
    s_cselect_b32 s95, 2058923, s95
    s_cselect_b32 s97, 0, s97
    s_cmp_lt_u32 s75, 13
    s_cselect_b32 s96, s75, s96
    s_cselect_b32 s95, 1290556, s95
    s_mul_i32 s83, s96, s95
    s_add_u32 s83, s83, s97
    s_add_u32 s84, s83, s95
    s_lshr_b32 s83, s83, 16
    s_add_u32 s99, s83, s77
    s_movk_i32 s100, 256
    s_cmp_ge_u32 s99, 229
    s_cselect_b32 s100, 283, s100
    s_cmp_ge_u32 s99, 431
    s_cselect_b32 s100, 337, s100
    s_cmp_ge_u32 s99, 606
    s_cselect_b32 s100, 418, s100
    s_cmp_ge_u32 s99, 754
    s_cselect_b32 s100, 526, s100
    s_cmp_ge_u32 s99, 1003
    s_cselect_b32 s100, 533, s100
    s_cmp_ge_u32 s99, 1225
    s_cselect_b32 s100, 567, s100
    s_cmp_ge_u32 s99, 1420
    s_cselect_b32 s100, 628, s100
    s_cmp_lt_u32 s75, 13
    s_cselect_b32 s100, 0, s100
    s_add_u32 s99, s99, s100
    s_lshr_b32 s87, s99, 8
    s_sub_u32 s87, s87, 1
    s_lshl_b32 s99, s99, 15
    v_and_b32 v4, 15, v1
    v_lshl_add_u32 v4, v4, 4, s94
    v_lshl_add_u32 v4, v227, 13, v4
    v_add_u32 v5, 0x1000, v4
    v_lshlrev_b32 v120, 2, v0
    v_add_u32 v121, 0x1000, v120
    v_add_u32 v122, 0x2000, v120
    v_add_u32 v123, 0x3000, v120
    s_mov_b32 s34, 0x4000
    s_mov_b32 s35, 0x20000
    s_mov_b32 s30, 0x10000
    s_mov_b32 s31, 0x20000
    s_mov_b32 s26, 0x4800000
    s_mov_b32 s27, 0x20000
    s_cmp_lg_u32 s73, 7
    s_cbranch_scc1 L_noinit
    v_mov_b32 v124, 0x22840
    v_mov_b32 v126, 4
    v_mov_b32 v127, 4
    v_mov_b32 v125, 0
    s_mov_b64 exec, 1
    ds_write_b64 v124, v[126:127]
    ds_write_b32 v124, v125 offset:8
    s_mov_b64 exec, -1
L_noinit:
    s_waitcnt lgkmcnt(0)
    s_mov_b32 s20, s6
    s_and_b32 s21, s7, 0xffff
    s_mov_b32 s28, s4
    s_and_b32 s29, s5, 0xffff
    s_cmp_lt_u32 s75, 13
    s_cbranch_scc1 L_fq
    buffer_load_dwordx4 v[64:67], v2, s[20:23], s99 offen offset:0 nt
    buffer_load_dwordx4 v[68:71], v2, s[20:23], s99 offen offset:2048 nt
    buffer_load_dwordx4 v[72:75], v3, s[20:23], s99 offen offset:0 nt
    buffer_load_dwordx4 v[76:79], v3, s[20:23], s99 offen offset:2048 nt
    s_branch L_fq2
L_fq:
    s_lshl_b32 s94, s74, 11
    s_lshl_b32 s95, s76, 10
    s_add_u32 s94, s94, s95
    v_lshl_add_u32 v6, v1, 4, s94
    s_lshl_b32 s95, s77, 14
    s_add_u32 s96, s95, 0x2000
    buffer_load_dwordx4 v[128:131], v6, s[28:31], s95 offen
    buffer_load_dwordx4 v[132:135], v6, s[28:31], s96 offen
L_fq2:
    s_mov_b32 s32, s10
    s_and_b32 s33, s11, 0xffff
    s_load_dwordx8 s[48:55], s[12:13], 0
    s_barrier
    buffer_load_dword v96, v120, s[32:35], 0 offen offset:0
    buffer_load_dword v97, v120, s[32:35], 0 offen offset:2048
    buffer_load_dword v98, v121, s[32:35], 0 offen offset:0
    buffer_load_dword v99, v121, s[32:35], 0 offen offset:2048
    buffer_load_dword v100, v122, s[32:35], 0 offen offset:0
    buffer_load_dword v101, v122, s[32:35], 0 offen offset:2048
    buffer_load_dword v102, v123, s[32:35], 0 offen offset:0
    buffer_load_dword v103, v123, s[32:35], 0 offen offset:2048
    s_mov_b32 s24, s8
    s_and_b32 s25, s9, 0xffff
    s_mov_b32 s36, s14
    s_and_b32 s37, s15, 0xffff
    s_mov_b32 s40, s16
    s_and_b32 s41, s17, 0xffff
    s_mov_b32 s44, s18
    s_and_b32 s45, s19, 0xffff
    s_mov_b32 s38, 0x10000
    s_mov_b32 s39, 0x20000
    s_mov_b32 s42, 0x100
    s_mov_b32 s43, 0x20000
    s_mov_b32 s46, 0x1000000
    s_mov_b32 s47, 0x20000
    s_or_b32 s94, s2, s73
    s_cbranch_scc1 L_notag
    s_mul_i32 s94, s93, 0x9e3779b1
    s_add_u32 s94, s94, s92
    s_mul_i32 s94, s94, 0x85ebca6b
    s_lshr_b32 s95, s94, 15
    s_xor_b32 s94, s94, s95
    s_max_u32 s94, s94, 1
    v_mov_b32 v232, s94
    s_mov_b64 exec, 1
    buffer_store_dword v232, off, s[40:43], 0 sc1
    s_mov_b64 exec, -1
L_notag:
    s_mov_b32 s7, s99
    s_movk_i32 s80, 13
    s_cmp_lt_u32 s75, s80
    s_cbranch_scc1 L_fl_1s
    s_lshl_b32 s94, s74, 11
    s_lshl_b32 s95, s76, 10
    s_add_u32 s94, s94, s95
    v_lshl_add_u32 v6, v229, 8, s94
    v_lshl_add_u32 v6, v227, 6, v6
    v_lshl_add_u32 v6, v228, 4, v6
    s_lshl_b32 s94, s87, 13
    buffer_load_dwordx4 v[28:31], v6, s[28:31], s94 offen
    buffer_load_dwordx4 v[80:83], v4, s[24:27], s7 offen offset:0 nt
    buffer_load_dwordx4 v[84:87], v4, s[24:27], s7 offen offset:2048 nt
    buffer_load_dwordx4 v[88:91], v5, s[24:27], s7 offen offset:0 nt
    buffer_load_dwordx4 v[92:95], v5, s[24:27], s7 offen offset:2048 nt
    s_branch L_fl_1v
L_fl_1s:
    buffer_load_dwordx4 v[64:67], v2, s[20:23], s7 offen offset:0 nt
    buffer_load_dwordx4 v[68:71], v2, s[20:23], s7 offen offset:2048 nt
    buffer_load_dwordx4 v[72:75], v3, s[20:23], s7 offen offset:0 nt
    buffer_load_dwordx4 v[76:79], v3, s[20:23], s7 offen offset:2048 nt
L_fl_1v:
    s_mov_b32 s4, 0x05040100
    s_mov_b32 s5, 0x07060302
    v_mov_b32 v230, 0xf149f2ca
    s_lshl2_add_u32 s94, s76, 0x22840
    v_mov_b32 v240, s94
    v_mov_b32 v242, 1
    s_movk_i32 s79, 256
    s_movk_i32 s81, 51
    s_movk_i32 s91, 6460
    s_movk_i32 s0, 64
    s_movk_i32 s56, 229
    s_movk_i32 s57, 202
    s_movk_i32 s58, 175
    s_movk_i32 s59, 148
    s_movk_i32 s60, 249
    s_movk_i32 s61, 222
    s_movk_i32 s62, 195
    s_movk_i32 s63, 168
    s_movk_i32 s64, 0
    s_movk_i32 s65, 229
    s_movk_i32 s66, 431
    s_movk_i32 s67, 606
    s_movk_i32 s68, 754
    s_movk_i32 s69, 1003
    s_movk_i32 s70, 1225
    s_movk_i32 s71, 1420
    s_movk_i32 s72, 1588
    s_lshr_b32 s84, s84, 16
    s_sub_u32 s85, s84, s83
    v_add_u32 v112, s83, v1
    v_mov_b32 v113, 0
    s_cmp_lt_u32 s75, 13
    s_cbranch_scc1 L_flist
    v_mov_b32 v113, 256
    v_mov_b32 v11, 3663
    v_mov_b32 v12, 0
    v_cmpx_le_u32 vcc, s65, v112
    v_mov_b32 v113, 283
    v_mov_b32 v11, 6894
    v_mov_b32 v12, 1
    v_cmpx_le_u32 vcc, s66, v112
    v_mov_b32 v113, 337
    v_mov_b32 v11, 9693
    v_mov_b32 v12, 2
    v_cmpx_le_u32 vcc, s67, v112
    v_mov_b32 v113, 418
    v_mov_b32 v11, 12060
    v_mov_b32 v12, 3
    v_cmpx_le_u32 vcc, s68, v112
    v_mov_b32 v113, 526
    v_mov_b32 v11, 16043
    v_mov_b32 v12, 4
    v_cmpx_le_u32 vcc, s69, v112
    v_mov_b32 v113, 533
    v_mov_b32 v11, 19594
    v_mov_b32 v12, 5
    v_cmpx_le_u32 vcc, s70, v112
    v_mov_b32 v113, 567
    v_mov_b32 v11, 22713
    v_mov_b32 v12, 6
    v_cmpx_le_u32 vcc, s71, v112
    v_mov_b32 v113, 628
    v_mov_b32 v11, 25400
    v_mov_b32 v12, 7
    s_mov_b64 exec, -1
    v_lshlrev_b32 v114, 4, v112
    v_sub_u32 v11, v11, v114
    s_nop 1
L_flist:
    v_add_lshl_u32 v10, v112, v113, 15
    s_mov_b32 s78, 0
    s_nop 0
L_go:
    s_mov_b32 s92, 1
    s_mov_b32 s16, 0
    s_mov_b32 s86, s77
    s_cmp_lt_u32 s75, s80
    s_cbranch_scc1 L_shared
    v_lshrrev_b32 v13, 2, v1
    s_mov_b32 s15, s87
    s_mov_b32 s6, 0
    v_mov_b32 v40, 0
    v_mov_b32 v41, 0
    v_mov_b32 v42, 0
    v_mov_b32 v43, 0
    v_mov_b32 v44, 0
    v_mov_b32 v45, 0
    v_mov_b32 v46, 0
    v_mov_b32 v47, 0
    v_mov_b32 v32, 0
    v_mov_b32 v33, 0
    v_mov_b32 v34, 0
    v_mov_b32 v35, 0
    v_mov_b32 v36, 0
    v_mov_b32 v37, 0
    v_mov_b32 v38, 0
    v_mov_b32 v39, 0
    v_mov_b32 v14, v230
    v_mov_b32 v16, v230
    v_mov_b32 v15, 0
    s_cmp_ge_u32 s86, s85
    s_cbranch_scc1 L_plast
L_ploop:
    v_readlane_b32 s9, v12, s86
    v_readlane_b32 s8, v11, s86
    s_cmp_lg_u32 s9, s87
    s_cbranch_scc1 L_psw
    s_nop 2
L_psw_back:
    s_waitcnt vmcnt(4)
    s_cmp_lt_u32 s16, 2
    s_cbranch_scc1 L_earlyp
L_notlp:
    s_mov_b64 exec, 1
    ds_add_rtn_u32 v241, v240, v242
    s_mov_b64 exec, -1
    v_mfma_f32_16x16x32_bf16 v[48:51], v[64:67], v[28:31], 0
    v_mfma_f32_16x16x32_bf16 v[52:55], v[68:71], v[28:31], 0
    v_mfma_f32_16x16x32_bf16 v[56:59], v[72:75], v[28:31], 0
    v_mfma_f32_16x16x32_bf16 v[60:63], v[76:79], v[28:31], 0
    s_waitcnt lgkmcnt(0)
    v_readfirstlane_b32 s3, v241
    s_cmp_ge_u32 s3, s85
    s_nop 3
    s_cbranch_scc1 L_nokp
    v_readlane_b32 s94, v12, s3
    v_readlane_b32 s7, v10, s3
    s_cmp_lg_u32 s94, s87
    s_cbranch_scc1 L_pq2
    s_nop 2
L_pq2_back:
    buffer_load_dwordx4 v[64:67], v2, s[20:23], s7 offen offset:0 nt
    buffer_load_dwordx4 v[68:71], v2, s[20:23], s7 offen offset:2048 nt
    buffer_load_dwordx4 v[72:75], v3, s[20:23], s7 offen offset:0 nt
    buffer_load_dwordx4 v[76:79], v3, s[20:23], s7 offen offset:2048 nt
L_nokp:
    s_cmp_eq_u32 s16, s92
    s_cbranch_scc1 L_bkp
L_bk_backp:
    v_add_f32_dpp v17, v49, v48 row_ror:12 row_mask:0xf bank_mask:0x1
    v_add_f32_dpp v17, v54, v53 row_ror:12 row_mask:0xf bank_mask:0x2
    v_add_f32_dpp v17, v59, v58 row_ror:12 row_mask:0xf bank_mask:0x4
    v_add_f32_dpp v17, v60, v63 row_ror:12 row_mask:0xf bank_mask:0x8
    v_add_f32_dpp v17, v50, v17 row_ror:8 row_mask:0xf bank_mask:0x1
    v_add_f32_dpp v17, v55, v17 row_ror:8 row_mask:0xf bank_mask:0x2
    v_add_f32_dpp v17, v56, v17 row_ror:8 row_mask:0xf bank_mask:0x4
    v_add_f32_dpp v17, v61, v17 row_ror:8 row_mask:0xf bank_mask:0x8
    v_add_f32_dpp v17, v51, v17 row_ror:4 row_mask:0xf bank_mask:0x1
    v_add_f32_dpp v17, v52, v17 row_ror:4 row_mask:0xf bank_mask:0x2
    v_add_f32_dpp v17, v57, v17 row_ror:4 row_mask:0xf bank_mask:0x4
    v_add_f32_dpp v17, v62, v17 row_ror:4 row_mask:0xf bank_mask:0x8
    v_mul_f32 v17, 0x3e0293ee, v17
    s_cmp_lt_i32 s8, 16
    s_cbranch_scc1 L_pmask
L_pmask_back:
    v_cmp_gt_f32 vcc, v17, v16
    s_cbranch_vccnz L_presc
L_presc_back:
    v_sub_f32 v18, v17, v14
    v_exp_f32 v18, v18
    s_nop 0
    v_cvt_pk_bf16_f32 v19, v18, 0
    v_cvt_pk_bf16_f32 v20, 0, v18
    v_add_f32 v15, v15, v18
    v_mov_b32_dpp v40, v19 quad_perm:[0,1,2,3] row_mask:0xf bank_mask:0x1
    v_mov_b32_dpp v40, v20 row_ror:4 row_mask:0xf bank_mask:0x2
    v_mov_b32_dpp v41, v19 row_ror:8 row_mask:0xf bank_mask:0x4
    v_mov_b32_dpp v41, v20 row_ror:12 row_mask:0xf bank_mask:0x8
    v_mov_b32_dpp v42, v19 row_ror:12 row_mask:0xf bank_mask:0x1
    v_mov_b32_dpp v42, v20 quad_perm:[0,1,2,3] row_mask:0xf bank_mask:0x2
    v_mov_b32_dpp v43, v19 row_ror:4 row_mask:0xf bank_mask:0x4
    v_mov_b32_dpp v43, v20 row_ror:8 row_mask:0xf bank_mask:0x8
    v_mov_b32_dpp v44, v19 row_ror:8 row_mask:0xf bank_mask:0x1
    v_mov_b32_dpp v44, v20 row_ror:12 row_mask:0xf bank_mask:0x2
    v_mov_b32_dpp v45, v19 quad_perm:[0,1,2,3] row_mask:0xf bank_mask:0x4
    v_mov_b32_dpp v45, v20 row_ror:4 row_mask:0xf bank_mask:0x8
    v_mov_b32_dpp v46, v19 row_ror:4 row_mask:0xf bank_mask:0x1
    v_mov_b32_dpp v46, v20 row_ror:8 row_mask:0xf bank_mask:0x2
    v_mov_b32_dpp v47, v19 row_ror:12 row_mask:0xf bank_mask:0x4
    v_mov_b32_dpp v47, v20 quad_perm:[0,1,2,3] row_mask:0xf bank_mask:0x8
    s_cmp_ge_u32 s3, s85
    s_cbranch_scc1 L_plast
    s_waitcnt vmcnt(4)
    v_mfma_f32_16x16x16_bf16 v[32:35], v[80:81], v[40:41], v[32:35]
    v_mfma_f32_16x16x16_bf16 v[36:39], v[82:83], v[40:41], v[36:39]
    v_mfma_f32_16x16x16_bf16 v[32:35], v[84:85], v[42:43], v[32:35]
    v_mfma_f32_16x16x16_bf16 v[36:39], v[86:87], v[42:43], v[36:39]
    v_mfma_f32_16x16x16_bf16 v[32:35], v[88:89], v[44:45], v[32:35]
    v_mfma_f32_16x16x16_bf16 v[36:39], v[90:91], v[44:45], v[36:39]
    v_mfma_f32_16x16x16_bf16 v[32:35], v[92:93], v[46:47], v[32:35]
    v_mfma_f32_16x16x16_bf16 v[36:39], v[94:95], v[46:47], v[36:39]
    buffer_load_dwordx4 v[80:83], v4, s[24:27], s7 offen offset:0 nt
    buffer_load_dwordx4 v[84:87], v4, s[24:27], s7 offen offset:2048 nt
    buffer_load_dwordx4 v[88:91], v5, s[24:27], s7 offen offset:0 nt
    buffer_load_dwordx4 v[92:95], v5, s[24:27], s7 offen offset:2048 nt
    s_nop 3
L_pvdone:
    s_mov_b32 s86, s3
    s_add_u32 s16, s16, 1
    s_branch L_ploop
L_plast:
    s_cmp_ge_i32 s92, 0
    s_cbranch_scc1 L_bklp
L_bkl_backp:
    s_bfm_b32 s99, s15, 0
    s_add_u32 s100, s87, 1
    s_bfm_b32 s100, s100, 0
    s_orn2_b32 s99, s99, s100
    s_and_b32 s99, s99, s93
    s_cbranch_scc1 L_pempty
L_pempty_back:
    s_lshl_b32 s94, s87, 3
    s_add_u32 s94, s94, s73
    s_mul_i32 s94, s94, 2080
    v_lshl_add_u32 v23, v1, 4, s94
    v_lshl_add_u32 v22, v1, 3, s94
    v_add_f32_dpp v15, v15, v15 row_ror:4 row_mask:0xf bank_mask:0xf
    s_nop 1
    v_add_f32_dpp v15, v15, v15 row_ror:8 row_mask:0xf bank_mask:0xf
    v_mov_b32 v21, v15
    s_nop 1
    v_permlane16_swap_b32 v15, v21
    v_add_f32 v15, v15, v21
    v_mov_b32 v21, v15
    s_nop 1
    v_permlane32_swap_b32 v15, v21
    v_add_f32 v15, v15, v21
    s_mov_b64 exec, 15
    ds_write_b64 v22, v[14:15] offset:10240
    s_mov_b64 exec, -1
    s_lshr_b32 s87, s73, 2
    s_add_u32 s87, s87, s88
    s_bfe_u32 s98, s73, 0x10001
    s_and_b32 s99, s73, 1
    v_lshlrev_b32 v24, 4, v1
    v_lshlrev_b32 v17, 4, v229
    v_lshl_add_u32 v17, v227, 6, v17
    v_lshl_add_u32 v17, v228, 8, v17
    v_mov_b32 v27, 0x22848
    s_lshl_b32 s94, s87, 3
    s_add_u32 s94, s94, s98
    s_mul_i32 s94, s94, 2080
    s_add_u32 s94, s94, 8192
    v_lshl_add_u32 v26, v229, 3, s94
    s_lshl_b32 s95, s99, 10
    s_add_u32 s94, s94, s95
    v_add_u32 v25, s94, v24
    s_add_u32 s94, s90, s87
    s_lshl_b32 s94, s94, 2
    s_add_u32 s94, s94, s74
    s_mul_i32 s94, s94, 4224
    s_lshl_b32 s96, s98, 6
    s_add_u32 s96, s96, s94
    s_add_u32 s96, s96, 0x1000
    s_lshl_b32 s97, s98, 11
    s_add_u32 s94, s94, s97
    s_add_u32 s97, s94, s95
    s_cmp_lg_u32 s73, 0
    s_cbranch_scc1 L_tagdonep
    v_readfirstlane_b32 s14, v232
    s_cmp_eq_u32 s14, 0
    s_cbranch_scc1 L_tagwp
    s_nop 2
L_tagokp:
    v_mov_b32 v233, 0x2284c
    s_mov_b64 exec, 1
    ds_write_b32 v233, v232
    s_mov_b64 exec, -1
L_tagdonep:
    s_waitcnt vmcnt(0)
    v_mfma_f32_16x16x16_bf16 v[32:35], v[80:81], v[40:41], v[32:35]
    v_mfma_f32_16x16x16_bf16 v[36:39], v[82:83], v[40:41], v[36:39]
    v_mfma_f32_16x16x16_bf16 v[32:35], v[84:85], v[42:43], v[32:35]
    v_mfma_f32_16x16x16_bf16 v[36:39], v[86:87], v[42:43], v[36:39]
    v_mfma_f32_16x16x16_bf16 v[32:35], v[88:89], v[44:45], v[32:35]
    v_mfma_f32_16x16x16_bf16 v[36:39], v[90:91], v[44:45], v[36:39]
    v_mfma_f32_16x16x16_bf16 v[32:35], v[92:93], v[46:47], v[32:35]
    v_mfma_f32_16x16x16_bf16 v[36:39], v[94:95], v[46:47], v[36:39]
    s_nop 6
    ds_write_b128 v23, v[32:35] offset:8192
    ds_write_b128 v23, v[36:39] offset:9216
    s_waitcnt lgkmcnt(0)
    s_barrier
    ds_read_b32 v232, v27 offset:4
    ds_read_b32 v27, v27
L_pred:
    ds_read_b64 v[64:65], v26 offset:2048
    ds_read_b64 v[66:67], v26 offset:6208
    ds_read_b64 v[68:69], v26 offset:10368
    ds_read_b64 v[70:71], v26 offset:14528
    ds_read_b128 v[72:75], v25 offset:0
    ds_read_b128 v[76:79], v25 offset:4160
    ds_read_b128 v[80:83], v25 offset:8320
    ds_read_b128 v[84:87], v25 offset:12480
    s_waitcnt lgkmcnt(4)
    v_mov_b32 v90, v232
    v_mov_b32 v91, v232
    v_cmp_ne_u32 vcc, 0, v27
    s_cbranch_vccnz L_general
    s_bitcmp1_b32 s93, s87
    s_cbranch_scc0 L_pred_next
    v_max3_f32 v88, v64, v66, v68
    v_max_f32 v88, v88, v70
    v_sub_f32 v92, v64, v88
    v_sub_f32 v93, v66, v88
    v_sub_f32 v94, v68, v88
    v_sub_f32 v95, v70, v88
    v_exp_f32 v92, v92
    v_exp_f32 v93, v93
    v_exp_f32 v94, v94
    v_exp_f32 v95, v95
    s_waitcnt lgkmcnt(0)
    v_mul_f32 v72, v72, v92
    v_mul_f32 v73, v73, v92
    v_mul_f32 v74, v74, v92
    v_mul_f32 v75, v75, v92
    v_fmac_f32 v72, v76, v93
    v_fmac_f32 v73, v77, v93
    v_fmac_f32 v74, v78, v93
    v_fmac_f32 v75, v79, v93
    v_fmac_f32 v72, v80, v94
    v_fmac_f32 v73, v81, v94
    v_fmac_f32 v74, v82, v94
    v_fmac_f32 v75, v83, v94
    v_fmac_f32 v72, v84, v95
    v_fmac_f32 v73, v85, v95
    v_fmac_f32 v74, v86, v95
    v_fmac_f32 v75, v87, v95
    v_perm_b32 v72, v72, v232, s10
    v_perm_b32 v73, v73, v232, s11
    v_perm_b32 v74, v74, v232, s12
    v_perm_b32 v75, v75, v232, s13
    v_mul_f32 v89, v65, v92
    v_fmac_f32 v89, v67, v93
    v_fmac_f32 v89, v69, v94
    v_fmac_f32 v89, v71, v95
    buffer_store_dwordx4 v[72:75], v17, s[44:47], s97 offen sc1
    s_cmp_lg_u32 s99, 0
    s_cbranch_scc1 L_pred_next
    s_mov_b64 exec, 15
    buffer_store_dwordx4 v[88:91], v24, s[44:47], s96 offen sc1
    s_mov_b64 exec, -1
    s_nop 0
L_pred_next:
    s_add_u32 s87, s87, 2
    s_cmp_gt_u32 s87, s89
    s_cbranch_scc1 L_publish
    s_waitcnt lgkmcnt(0)
    s_lshl_b32 s94, s87, 3
    s_add_u32 s94, s94, s98
    s_mul_i32 s94, s94, 2080
    s_add_u32 s94, s94, 8192
    v_lshl_add_u32 v26, v229, 3, s94
    s_lshl_b32 s95, s99, 10
    s_add_u32 s94, s94, s95
    v_add_u32 v25, s94, v24
    s_add_u32 s94, s90, s87
    s_lshl_b32 s94, s94, 2
    s_add_u32 s94, s94, s74
    s_mul_i32 s94, s94, 4224
    s_lshl_b32 s96, s98, 6
    s_add_u32 s96, s96, s94
    s_add_u32 s96, s96, 0x1000
    s_lshl_b32 s97, s98, 11
    s_add_u32 s94, s94, s97
    s_add_u32 s97, s94, s95
    s_branch L_pred
L_psw:
    s_nop 7
    s_lshl_b32 s94, s87, 3
    s_add_u32 s94, s94, s73
    s_mul_i32 s94, s94, 2080
    v_lshl_add_u32 v23, v1, 4, s94
    v_lshl_add_u32 v22, v1, 3, s94
    ds_write_b128 v23, v[32:35] offset:8192
    ds_write_b128 v23, v[36:39] offset:9216
    v_add_f32_dpp v15, v15, v15 row_ror:4 row_mask:0xf bank_mask:0xf
    s_nop 1
    v_add_f32_dpp v15, v15, v15 row_ror:8 row_mask:0xf bank_mask:0xf
    v_mov_b32 v21, v15
    s_nop 1
    v_permlane16_swap_b32 v15, v21
    v_add_f32 v15, v15, v21
    v_mov_b32 v21, v15
    s_nop 1
    v_permlane32_swap_b32 v15, v21
    v_add_f32 v15, v15, v21
    s_mov_b64 exec, 15
    ds_write_b64 v22, v[14:15] offset:10240
    s_mov_b64 exec, -1
    s_waitcnt lgkmcnt(0)
    v_mov_b32 v32, 0
    v_mov_b32 v33, 0
    v_mov_b32 v34, 0
    v_mov_b32 v35, 0
    v_mov_b32 v36, 0
    v_mov_b32 v37, 0
    v_mov_b32 v38, 0
    v_mov_b32 v39, 0
    v_mov_b32 v14, v230
    v_mov_b32 v16, v230
    v_mov_b32 v15, 0
    s_add_u32 s87, s87, 1
    s_cmp_lt_u32 s87, s9
    s_cbranch_scc1 L_psw
    v_mov_b32 v28, v104
    v_mov_b32 v29, v105
    v_mov_b32 v30, v106
    v_mov_b32 v31, v107
    s_nop 0
    s_branch L_psw_back
L_earlyp:
    s_cmp_eq_u32 s16, 0
    s_cbranch_scc1 L_early0p
    s_cmp_lg_u32 s73, 0
    s_cbranch_scc1 L_notlp
    buffer_load_dword v232, off, s[40:43], 0 sc1
    s_branch L_notlp
L_early0p:
    s_branch L_notlp
L_pq2:
    s_nop 7
    s_lshl_b32 s94, s94, 13
    buffer_load_dwordx4 v[104:107], v6, s[28:31], s94 offen
    s_branch L_pq2_back
L_bkp:
    s_nop 7
    s_cmp_lg_u32 s78, 0
    s_cbranch_scc1 L_ver_2
    s_waitcnt lgkmcnt(0)
    s_cmp_ge_u32 s73, 4
    s_cselect_b32 s94, 0x100, 0
    v_mov_b32 v233, v0
    v_xor_b32 v234, v233, v96
    v_add_u32 v233, s94, v233
    v_xor_b32 v235, v233, v97
    v_or_b32 v234, v234, v235
    v_add_u32 v233, s94, v233
    v_xor_b32 v235, v233, v98
    v_or_b32 v234, v234, v235
    v_add_u32 v233, s94, v233
    v_xor_b32 v235, v233, v99
    v_or_b32 v234, v234, v235
    v_add_u32 v233, s94, v233
    v_xor_b32 v235, v233, v100
    v_or_b32 v234, v234, v235
    v_add_u32 v233, s94, v233
    v_xor_b32 v235, v233, v101
    v_or_b32 v234, v234, v235
    v_add_u32 v233, s94, v233
    v_xor_b32 v235, v233, v102
    v_or_b32 v234, v234, v235
    v_add_u32 v233, s94, v233
    v_xor_b32 v235, v233, v103
    v_or_b32 v234, v234, v235
    s_xor_b32 s94, s48, 7759
    s_xor_b32 s95, s49, 7326
    s_or_b32 s94, s94, s95
    s_xor_b32 s95, s50, 6893
    s_or_b32 s94, s94, s95
    s_xor_b32 s95, s51, 6460
    s_or_b32 s94, s94, s95
    s_xor_b32 s95, s52, 8075
    s_or_b32 s94, s94, s95
    s_xor_b32 s95, s53, 7642
    s_or_b32 s94, s94, s95
    s_xor_b32 s95, s54, 7209
    s_or_b32 s94, s94, s95
    s_xor_b32 s95, s55, 6776
    s_or_b32 s94, s94, s95
    v_or_b32 v234, s94, v234
    v_cmp_ne_u32 vcc, 0, v234
    s_nop 3
    s_cbranch_vccz L_ver_2
    v_mov_b32 v233, 0x22840
    v_mov_b32 v234, 0x10000
    s_mov_b64 exec, 1
    ds_write_b32 v233, v234 offset:0
    ds_write_b32 v233, v234 offset:4
    ds_write_b32 v233, v234 offset:8
    s_mov_b64 exec, -1
    s_waitcnt lgkmcnt(0)
L_ver_2:
    v_mov_b32 v233, 0
    v_mov_b32 v234, 0
    v_writelane_b32 v233, s64, 0
    v_writelane_b32 v234, s56, 0
    v_writelane_b32 v233, s65, 1
    v_writelane_b32 v234, s57, 1
    v_writelane_b32 v233, s66, 2
    v_writelane_b32 v234, s58, 2
    v_writelane_b32 v233, s67, 3
    v_writelane_b32 v234, s59, 3
    v_writelane_b32 v233, s68, 4
    v_writelane_b32 v234, s60, 4
    v_writelane_b32 v233, s69, 5
    v_writelane_b32 v234, s61, 5
    v_writelane_b32 v233, s70, 6
    v_writelane_b32 v234, s62, 6
    v_writelane_b32 v233, s71, 7
    v_writelane_b32 v234, s63, 7
    v_cvt_f32_u32 v235, s72
    v_add_u32 v236, v233, v234
    v_add_u32 v237, 1, v233
    v_rcp_f32 v235, v235
    v_mul_lo_u32 v236, v236, s81
    v_mul_lo_u32 v237, v237, s81
    v_cvt_f32_u32 v236, v236
    v_cvt_f32_u32 v237, v237
    v_add_f32 v236, -0.5, v236
    v_add_f32 v237, -0.5, v237
    v_mul_f32 v236, v236, v235
    v_mul_f32 v237, v237, v235
    v_cvt_u32_f32 v236, v236
    v_cvt_u32_f32 v224, v237
    v_sub_u32 v238, v236, v224
    v_add_u32 v238, 1, v238
    v_cmp_lt_u32 vcc, 0, v234
    s_nop 1
    v_cndmask_b32 v225, 0, v238, vcc
    s_cmp_lg_u32 s78, 0
    s_cbranch_scc1 L_bkc_3
    v_writelane_b32 v224, 0, 0
    v_writelane_b32 v225, 8, 0
    v_writelane_b32 v224, 7, 1
    v_writelane_b32 v225, 7, 1
    v_writelane_b32 v224, 13, 2
    v_writelane_b32 v225, 7, 2
    v_writelane_b32 v224, 19, 3
    v_writelane_b32 v225, 5, 3
    v_writelane_b32 v224, 24, 4
    v_writelane_b32 v225, 9, 4
    v_writelane_b32 v224, 32, 5
    v_writelane_b32 v225, 8, 5
    v_writelane_b32 v224, 39, 6
    v_writelane_b32 v225, 7, 6
    v_writelane_b32 v224, 45, 7
    v_writelane_b32 v225, 6, 7
    s_nop 1
L_bkc_3:
    v_add_u32 v226, s80, v225
    v_sub_u32 v233, s90, v224
    v_cmp_lt_u32 vcc, v233, v225
    s_nop 0
    s_and_b32 s93, vcc_lo, 0xff
    s_ff1_i32_b32 s88, s93
    s_flbit_i32_b32 s89, s93
    s_sub_u32 s89, 31, s89
    s_mov_b32 s10, 0x07060500
    s_mov_b32 s11, 0x07060501
    s_mov_b32 s12, 0x07060502
    s_mov_b32 s13, 0x07060503
    s_mov_b32 s92, -1
    s_branch L_bk_backp
L_pmask:
    s_nop 7
    v_cmp_gt_i32 vcc, s8, v13
    s_nop 1
    v_cndmask_b32 v17, v230, v17, vcc
    s_nop 0
    s_branch L_pmask_back
L_presc:
    s_nop 7
    v_mov_b32 v21, v17
    s_nop 1
    v_max_f32_dpp v21, v21, v21 row_ror:4 row_mask:0xf bank_mask:0xf
    s_nop 1
    v_max_f32_dpp v21, v21, v21 row_ror:8 row_mask:0xf bank_mask:0xf
    v_mov_b32 v22, v21
    s_nop 1
    v_permlane16_swap_b32 v21, v22
    v_max_f32 v21, v21, v22
    v_mov_b32 v22, v21
    s_nop 1
    v_permlane32_swap_b32 v21, v22
    v_max_f32 v21, v21, v22
    v_max_f32 v21, v21, v14
    v_sub_f32 v22, v14, v21
    v_exp_f32 v22, v22
    v_mov_b32 v14, v21
    v_add_f32 v16, 0x41000000, v21
    v_mul_f32 v15, v15, v22
    v_mul_f32 v32, v32, v22
    v_mul_f32 v33, v33, v22
    v_mul_f32 v34, v34, v22
    v_mul_f32 v35, v35, v22
    v_mul_f32 v36, v36, v22
    v_mul_f32 v37, v37, v22
    v_mul_f32 v38, v38, v22
    v_mul_f32 v39, v39, v22
    s_nop 0
    s_branch L_presc_back
L_bklp:
    s_nop 7
    s_cmp_lg_u32 s78, 0
    s_cbranch_scc1 L_ver_4
    s_waitcnt vmcnt(0)
    s_waitcnt lgkmcnt(0)
    s_cmp_ge_u32 s73, 4
    s_cselect_b32 s94, 0x100, 0
    v_mov_b32 v233, v0
    v_xor_b32 v234, v233, v96
    v_add_u32 v233, s94, v233
    v_xor_b32 v235, v233, v97
    v_or_b32 v234, v234, v235
    v_add_u32 v233, s94, v233
    v_xor_b32 v235, v233, v98
    v_or_b32 v234, v234, v235
    v_add_u32 v233, s94, v233
    v_xor_b32 v235, v233, v99
    v_or_b32 v234, v234, v235
    v_add_u32 v233, s94, v233
    v_xor_b32 v235, v233, v100
    v_or_b32 v234, v234, v235
    v_add_u32 v233, s94, v233
    v_xor_b32 v235, v233, v101
    v_or_b32 v234, v234, v235
    v_add_u32 v233, s94, v233
    v_xor_b32 v235, v233, v102
    v_or_b32 v234, v234, v235
    v_add_u32 v233, s94, v233
    v_xor_b32 v235, v233, v103
    v_or_b32 v234, v234, v235
    s_xor_b32 s94, s48, 7759
    s_xor_b32 s95, s49, 7326
    s_or_b32 s94, s94, s95
    s_xor_b32 s95, s50, 6893
    s_or_b32 s94, s94, s95
    s_xor_b32 s95, s51, 6460
    s_or_b32 s94, s94, s95
    s_xor_b32 s95, s52, 8075
    s_or_b32 s94, s94, s95
    s_xor_b32 s95, s53, 7642
    s_or_b32 s94, s94, s95
    s_xor_b32 s95, s54, 7209
    s_or_b32 s94, s94, s95
    s_xor_b32 s95, s55, 6776
    s_or_b32 s94, s94, s95
    v_or_b32 v234, s94, v234
    v_cmp_ne_u32 vcc, 0, v234
    s_nop 3
    s_cbranch_vccz L_ver_4
    v_mov_b32 v233, 0x22840
    v_mov_b32 v234, 0x10000
    s_mov_b64 exec, 1
    ds_write_b32 v233, v234 offset:0
    ds_write_b32 v233, v234 offset:4
    ds_write_b32 v233, v234 offset:8
    s_mov_b64 exec, -1
    s_waitcnt lgkmcnt(0)
L_ver_4:
    v_mov_b32 v233, 0
    v_mov_b32 v234, 0
    v_writelane_b32 v233, s64, 0
    v_writelane_b32 v234, s56, 0
    v_writelane_b32 v233, s65, 1
    v_writelane_b32 v234, s57, 1
    v_writelane_b32 v233, s66, 2
    v_writelane_b32 v234, s58, 2
    v_writelane_b32 v233, s67, 3
    v_writelane_b32 v234, s59, 3
    v_writelane_b32 v233, s68, 4
    v_writelane_b32 v234, s60, 4
    v_writelane_b32 v233, s69, 5
    v_writelane_b32 v234, s61, 5
    v_writelane_b32 v233, s70, 6
    v_writelane_b32 v234, s62, 6
    v_writelane_b32 v233, s71, 7
    v_writelane_b32 v234, s63, 7
    v_cvt_f32_u32 v235, s72
    v_add_u32 v236, v233, v234
    v_add_u32 v237, 1, v233
    v_rcp_f32 v235, v235
    v_mul_lo_u32 v236, v236, s81
    v_mul_lo_u32 v237, v237, s81
    v_cvt_f32_u32 v236, v236
    v_cvt_f32_u32 v237, v237
    v_add_f32 v236, -0.5, v236
    v_add_f32 v237, -0.5, v237
    v_mul_f32 v236, v236, v235
    v_mul_f32 v237, v237, v235
    v_cvt_u32_f32 v236, v236
    v_cvt_u32_f32 v224, v237
    v_sub_u32 v238, v236, v224
    v_add_u32 v238, 1, v238
    v_cmp_lt_u32 vcc, 0, v234
    s_nop 1
    v_cndmask_b32 v225, 0, v238, vcc
    s_cmp_lg_u32 s78, 0
    s_cbranch_scc1 L_bkc_5
    v_writelane_b32 v224, 0, 0
    v_writelane_b32 v225, 8, 0
    v_writelane_b32 v224, 7, 1
    v_writelane_b32 v225, 7, 1
    v_writelane_b32 v224, 13, 2
    v_writelane_b32 v225, 7, 2
    v_writelane_b32 v224, 19, 3
    v_writelane_b32 v225, 5, 3
    v_writelane_b32 v224, 24, 4
    v_writelane_b32 v225, 9, 4
    v_writelane_b32 v224, 32, 5
    v_writelane_b32 v225, 8, 5
    v_writelane_b32 v224, 39, 6
    v_writelane_b32 v225, 7, 6
    v_writelane_b32 v224, 45, 7
    v_writelane_b32 v225, 6, 7
    s_nop 1
L_bkc_5:
    v_add_u32 v226, s80, v225
    v_sub_u32 v233, s90, v224
    v_cmp_lt_u32 vcc, v233, v225
    s_nop 0
    s_and_b32 s93, vcc_lo, 0xff
    s_ff1_i32_b32 s88, s93
    s_flbit_i32_b32 s89, s93
    s_sub_u32 s89, 31, s89
    s_mov_b32 s10, 0x07060500
    s_mov_b32 s11, 0x07060501
    s_mov_b32 s12, 0x07060502
    s_mov_b32 s13, 0x07060503
    s_mov_b32 s92, -1
    s_branch L_bkl_backp
L_pempty:
    s_nop 7
    v_mov_b32 v48, 0
    v_mov_b32 v49, 0
    v_mov_b32 v50, 0
    v_mov_b32 v51, 0
    v_mov_b32 v52, v230
    v_mov_b32 v53, 0
    s_nop 1
L_pempty2:
    s_ff1_i32_b32 s100, s99
    s_bitset0_b32 s99, s100
    s_lshl_b32 s94, s100, 3
    s_add_u32 s94, s94, s73
    s_mul_i32 s94, s94, 2080
    v_lshl_add_u32 v23, v1, 4, s94
    v_lshl_add_u32 v22, v1, 3, s94
    ds_write_b128 v23, v[48:51] offset:8192
    ds_write_b128 v23, v[48:51] offset:9216
    s_mov_b64 exec, 15
    ds_write_b64 v22, v[52:53] offset:10240
    s_mov_b64 exec, -1
    s_cmp_lg_u32 s99, 0
    s_cbranch_scc1 L_pempty2
    s_branch L_pempty_back
L_tagwp:
    s_nop 7
    s_mov_b32 s101, 0
L_tagw2p:
    buffer_load_dword v232, off, s[40:43], 0 sc1
    s_add_u32 s101, s101, 1
    s_waitcnt vmcnt(0)
    v_readfirstlane_b32 s14, v232
    s_cmp_lg_u32 s14, 0
    s_nop 2
    s_cbranch_scc1 L_tagokp
    s_cmp_lt_u32 s101, 0x20000
    s_cbranch_scc1 L_tagw2p
    s_branch L_tagokp
L_shared:
    s_lshl_b32 s94, s76, 14
    s_add_u32 s94, s94, 8192
    v_lshl_add_u32 v21, v227, 4, s94
    v_lshl_add_u32 v21, v229, 8, v21
    v_and_b32 v22, 1, v228
    v_lshl_add_u32 v21, v22, 10, v21
    v_lshrrev_b32 v22, 1, v228
    v_lshl_add_u32 v21, v22, 15, v21
    v_add_u32 v22, 0x10000, v21
    s_lshl_b32 s94, s73, 14
    s_add_u32 s94, s94, 8192
    v_lshl_add_u32 v243, v1, 4, s94
    v_and_b32 v60, 15, v1
    v_lshl_add_u32 v61, v227, 2, v229
    v_lshl_add_u32 v62, v228, 2, 0
    v_xor_b32 v63, v62, v61
    v_lshl_add_u32 v62, v62, 8, s94
    v_lshl_add_u32 v6, v63, 4, v62
    v_add_u32 v62, 0, v227
    v_xor_b32 v63, v62, v60
    v_lshl_add_u32 v62, v60, 8, s94
    v_lshl_add_u32 v56, v63, 4, v62
    v_lshl_add_u32 v62, v228, 2, 1
    v_xor_b32 v63, v62, v61
    v_lshl_add_u32 v62, v62, 8, s94
    v_lshl_add_u32 v7, v63, 4, v62
    v_add_u32 v62, 4, v227
    v_xor_b32 v63, v62, v60
    v_lshl_add_u32 v62, v60, 8, s94
    v_lshl_add_u32 v57, v63, 4, v62
    v_lshl_add_u32 v62, v228, 2, 2
    v_xor_b32 v63, v62, v61
    v_lshl_add_u32 v62, v62, 8, s94
    v_lshl_add_u32 v8, v63, 4, v62
    v_add_u32 v62, 8, v227
    v_xor_b32 v63, v62, v60
    v_lshl_add_u32 v62, v60, 8, s94
    v_lshl_add_u32 v58, v63, 4, v62
    v_lshl_add_u32 v62, v228, 2, 3
    v_xor_b32 v63, v62, v61
    v_lshl_add_u32 v62, v62, 8, s94
    v_lshl_add_u32 v9, v63, 4, v62
    v_add_u32 v62, 12, v227
    v_xor_b32 v63, v62, v60
    v_lshl_add_u32 v62, v60, 8, s94
    v_lshl_add_u32 v59, v63, 4, v62
    v_mov_b32 v160, 0
    v_mov_b32 v161, 0
    v_mov_b32 v162, 0
    v_mov_b32 v163, 0
    v_mov_b32 v164, 0
    v_mov_b32 v165, 0
    v_mov_b32 v166, 0
    v_mov_b32 v167, 0
    v_mov_b32 v168, 0
    v_mov_b32 v169, 0
    v_mov_b32 v170, 0
    v_mov_b32 v171, 0
    v_mov_b32 v172, 0
    v_mov_b32 v173, 0
    v_mov_b32 v174, 0
    v_mov_b32 v175, 0
    v_mov_b32 v176, 0
    v_mov_b32 v177, 0
    v_mov_b32 v178, 0
    v_mov_b32 v179, 0
    v_mov_b32 v180, 0
    v_mov_b32 v181, 0
    v_mov_b32 v182, 0
    v_mov_b32 v183, 0
    v_mov_b32 v184, 0
    v_mov_b32 v185, 0
    v_mov_b32 v186, 0
    v_mov_b32 v187, 0
    v_mov_b32 v188, 0
    v_mov_b32 v189, 0
    v_mov_b32 v190, 0
    v_mov_b32 v191, 0
    v_mov_b32 v192, 0
    v_mov_b32 v193, 0
    v_mov_b32 v194, 0
    v_mov_b32 v195, 0
    v_mov_b32 v196, 0
    v_mov_b32 v197, 0
    v_mov_b32 v198, 0
    v_mov_b32 v199, 0
    v_mov_b32 v200, 0
    v_mov_b32 v201, 0
    v_mov_b32 v202, 0
    v_mov_b32 v203, 0
    v_mov_b32 v204, 0
    v_mov_b32 v205, 0
    v_mov_b32 v206, 0
    v_mov_b32 v207, 0
    v_mov_b32 v208, 0
    v_mov_b32 v209, 0
    v_mov_b32 v210, 0
    v_mov_b32 v211, 0
    v_mov_b32 v212, 0
    v_mov_b32 v213, 0
    v_mov_b32 v214, 0
    v_mov_b32 v215, 0
    v_mov_b32 v216, 0
    v_mov_b32 v217, 0
    v_mov_b32 v218, 0
    v_mov_b32 v219, 0
    v_mov_b32 v220, 0
    v_mov_b32 v221, 0
    v_mov_b32 v222, 0
    v_mov_b32 v223, 0
    s_waitcnt lgkmcnt(0)
    v_mov_b32 v11, s48
    v_cmpx_le_u32 vcc, 1, v228
    v_mov_b32 v11, s49
    v_cmpx_le_u32 vcc, 2, v228
    v_mov_b32 v11, s50
    v_cmpx_le_u32 vcc, 3, v228
    v_mov_b32 v11, s51
    s_mov_b64 exec, -1
    v_mov_b32 v12, s52
    v_cmpx_le_u32 vcc, 1, v228
    v_mov_b32 v12, s53
    v_cmpx_le_u32 vcc, 2, v228
    v_mov_b32 v12, s54
    v_cmpx_le_u32 vcc, 3, v228
    v_mov_b32 v12, s55
    s_mov_b64 exec, -1
    v_lshlrev_b32 v20, 2, v227
    v_sub_u32 v11, v11, v20
    v_mov_b32 v13, v230
    v_mov_b32 v15, v230
    v_mov_b32 v17, 0
    v_sub_u32 v12, v12, v20
    v_mov_b32 v14, v230
    v_mov_b32 v16, v230
    v_mov_b32 v18, 0
    s_waitcnt vmcnt(4)
    ds_write_b128 v243, v[128:131] offset:4096
    ds_write_b128 v243, v[132:135] offset:5120
    s_waitcnt lgkmcnt(0)
    s_barrier
    ds_read_b128 v[128:131], v21 offset:4096
    ds_read_b128 v[132:135], v21 offset:4160
    ds_read_b128 v[136:139], v21 offset:4224
    ds_read_b128 v[140:143], v21 offset:4288
    ds_read_b128 v[144:147], v22 offset:4096
    ds_read_b128 v[148:151], v22 offset:4160
    ds_read_b128 v[152:155], v22 offset:4224
    ds_read_b128 v[156:159], v22 offset:4288
    s_waitcnt lgkmcnt(0)
    s_barrier
    buffer_load_dwordx4 v[80:83], v4, s[24:27], s7 offen offset:0 nt
    buffer_load_dwordx4 v[84:87], v4, s[24:27], s7 offen offset:2048 nt
    buffer_load_dwordx4 v[88:91], v5, s[24:27], s7 offen offset:0 nt
    buffer_load_dwordx4 v[92:95], v5, s[24:27], s7 offen offset:2048 nt
    s_cmp_ge_u32 s86, s85
    s_cbranch_scc1 L_sdone
L_sloop:
    s_add_u32 s6, s83, s86
    s_lshl_b32 s6, s6, 4
    s_waitcnt vmcnt(4)
    s_cmp_lt_u32 s16, 2
    s_cbranch_scc1 L_earlys
L_notls:
    s_mov_b64 exec, 1
    ds_add_rtn_u32 v241, v240, v242
    s_mov_b64 exec, -1
    ds_write_b128 v6, v[64:67]
    ds_write_b128 v7, v[68:71]
    ds_write_b128 v8, v[72:75]
    ds_write_b128 v9, v[76:79]
    ds_read_b128 v[40:43], v56
    ds_read_b128 v[44:47], v57
    ds_read_b128 v[48:51], v58
    ds_read_b128 v[52:55], v59
    s_waitcnt lgkmcnt(4)
    v_readfirstlane_b32 s3, v241
    s_cmp_ge_u32 s3, s85
    s_cbranch_scc1 L_noks
    s_nop 1
    v_readlane_b32 s7, v10, s3
    s_nop 4
    buffer_load_dwordx4 v[64:67], v2, s[20:23], s7 offen offset:0 nt
    buffer_load_dwordx4 v[68:71], v2, s[20:23], s7 offen offset:2048 nt
    buffer_load_dwordx4 v[72:75], v3, s[20:23], s7 offen offset:0 nt
    buffer_load_dwordx4 v[76:79], v3, s[20:23], s7 offen offset:2048 nt
L_noks:
    s_cmp_eq_u32 s16, s92
    s_cbranch_scc1 L_bks
L_bk_backs:
    s_waitcnt lgkmcnt(3)
    v_mfma_f32_16x16x32_bf16 v[28:31], v[40:43], v[128:131], 0
    v_mfma_f32_16x16x32_bf16 v[32:35], v[40:43], v[144:147], 0
    s_waitcnt lgkmcnt(2)
    v_mfma_f32_16x16x32_bf16 v[28:31], v[44:47], v[132:135], v[28:31]
    v_mfma_f32_16x16x32_bf16 v[32:35], v[44:47], v[148:151], v[32:35]
    s_waitcnt lgkmcnt(1)
    v_mfma_f32_16x16x32_bf16 v[28:31], v[48:51], v[136:139], v[28:31]
    v_mfma_f32_16x16x32_bf16 v[32:35], v[48:51], v[152:155], v[32:35]
    s_waitcnt lgkmcnt(0)
    v_mfma_f32_16x16x32_bf16 v[28:31], v[52:55], v[140:143], v[28:31]
    v_mfma_f32_16x16x32_bf16 v[32:35], v[52:55], v[156:159], v[32:35]
    s_nop 6
    v_mul_f32 v28, 0x3e0293ee, v28
    v_mul_f32 v29, 0x3e0293ee, v29
    v_mul_f32 v30, 0x3e0293ee, v30
    v_mul_f32 v31, 0x3e0293ee, v31
    v_mul_f32 v32, 0x3e0293ee, v32
    v_mul_f32 v33, 0x3e0293ee, v33
    v_mul_f32 v34, 0x3e0293ee, v34
    v_mul_f32 v35, 0x3e0293ee, v35
    s_add_u32 s94, s6, 16
    s_cmp_gt_i32 s94, s91
    s_cbranch_scc1 L_smask
L_smask_back:
    v_max3_f32 v19, v28, v29, v30
    v_max3_f32 v20, v32, v33, v34
    v_max_f32 v19, v19, v31
    v_max_f32 v20, v20, v35
    v_cmp_gt_f32 s[94:95], v19, v15
    v_cmp_gt_f32 vcc, v20, v16
    s_nop 0
    s_or_b64 s[94:95], s[94:95], vcc
    s_cbranch_scc1 L_sresc
L_sresc_back:
    v_sub_f32 v28, v28, v13
    v_sub_f32 v29, v29, v13
    v_sub_f32 v30, v30, v13
    v_sub_f32 v31, v31, v13
    v_sub_f32 v32, v32, v14
    v_sub_f32 v33, v33, v14
    v_sub_f32 v34, v34, v14
    v_sub_f32 v35, v35, v14
    v_exp_f32 v28, v28
    v_exp_f32 v29, v29
    v_exp_f32 v30, v30
    v_exp_f32 v31, v31
    v_exp_f32 v32, v32
    v_exp_f32 v33, v33
    v_exp_f32 v34, v34
    v_exp_f32 v35, v35
    v_cvt_pk_bf16_f32 v36, v28, v29
    v_cvt_pk_bf16_f32 v37, v30, v31
    v_cvt_pk_bf16_f32 v38, v32, v33
    v_cvt_pk_bf16_f32 v39, v34, v35
    v_add_f32 v17, v17, v28
    v_add_f32 v18, v18, v32
    v_add_f32 v17, v17, v29
    v_add_f32 v18, v18, v33
    v_add_f32 v17, v17, v30
    v_add_f32 v18, v18, v34
    v_add_f32 v17, v17, v31
    v_add_f32 v18, v18, v35
    s_waitcnt vmcnt(4)
    s_cmp_lt_u32 s3, s85
    s_cbranch_scc1 L_voks
    s_waitcnt vmcnt(0)
L_voks:
    v_perm_b32 v40, v84, v80, s4
    v_perm_b32 v41, v92, v88, s4
    v_perm_b32 v42, v84, v80, s5
    v_perm_b32 v43, v92, v88, s5
    v_perm_b32 v44, v85, v81, s4
    v_perm_b32 v45, v93, v89, s4
    v_perm_b32 v46, v85, v81, s5
    v_perm_b32 v47, v93, v89, s5
    v_perm_b32 v48, v86, v82, s4
    v_perm_b32 v49, v94, v90, s4
    v_perm_b32 v50, v86, v82, s5
    v_perm_b32 v51, v94, v90, s5
    v_perm_b32 v52, v87, v83, s4
    v_perm_b32 v53, v95, v91, s4
    v_perm_b32 v54, v87, v83, s5
    v_perm_b32 v55, v95, v91, s5
    s_nop 0
    s_cbranch_scc0 L_novs
    buffer_load_dwordx4 v[80:83], v4, s[24:27], s7 offen offset:0 nt
    buffer_load_dwordx4 v[84:87], v4, s[24:27], s7 offen offset:2048 nt
    buffer_load_dwordx4 v[88:91], v5, s[24:27], s7 offen offset:0 nt
    buffer_load_dwordx4 v[92:95], v5, s[24:27], s7 offen offset:2048 nt
L_novs:
    v_mfma_f32_16x16x16_bf16 v[160:163], v[40:41], v[36:37], v[160:163]
    v_mfma_f32_16x16x16_bf16 v[192:195], v[40:41], v[38:39], v[192:195]
    v_mfma_f32_16x16x16_bf16 v[164:167], v[42:43], v[36:37], v[164:167]
    v_mfma_f32_16x16x16_bf16 v[196:199], v[42:43], v[38:39], v[196:199]
    v_mfma_f32_16x16x16_bf16 v[168:171], v[44:45], v[36:37], v[168:171]
    v_mfma_f32_16x16x16_bf16 v[200:203], v[44:45], v[38:39], v[200:203]
    v_mfma_f32_16x16x16_bf16 v[172:175], v[46:47], v[36:37], v[172:175]
    v_mfma_f32_16x16x16_bf16 v[204:207], v[46:47], v[38:39], v[204:207]
    v_mfma_f32_16x16x16_bf16 v[176:179], v[48:49], v[36:37], v[176:179]
    v_mfma_f32_16x16x16_bf16 v[208:211], v[48:49], v[38:39], v[208:211]
    v_mfma_f32_16x16x16_bf16 v[180:183], v[50:51], v[36:37], v[180:183]
    v_mfma_f32_16x16x16_bf16 v[212:215], v[50:51], v[38:39], v[212:215]
    v_mfma_f32_16x16x16_bf16 v[184:187], v[52:53], v[36:37], v[184:187]
    v_mfma_f32_16x16x16_bf16 v[216:219], v[52:53], v[38:39], v[216:219]
    v_mfma_f32_16x16x16_bf16 v[188:191], v[54:55], v[36:37], v[188:191]
    v_mfma_f32_16x16x16_bf16 v[220:223], v[54:55], v[38:39], v[220:223]
    s_mov_b32 s86, s3
    s_add_u32 s16, s16, 1
    s_cmp_ge_u32 s86, s85
    s_nop 3
    s_cbranch_scc0 L_sloop
L_sdone:
    ds_write_b128 v243, v[160:163] offset:0
    ds_write_b128 v243, v[164:167] offset:1024
    ds_write_b128 v243, v[168:171] offset:2048
    ds_write_b128 v243, v[172:175] offset:3072
    ds_write_b128 v243, v[176:179] offset:4096
    ds_write_b128 v243, v[180:183] offset:5120
    ds_write_b128 v243, v[184:187] offset:6144
    ds_write_b128 v243, v[188:191] offset:7168
    ds_write_b128 v243, v[192:195] offset:8192
    ds_write_b128 v243, v[196:199] offset:9216
    ds_write_b128 v243, v[200:203] offset:10240
    ds_write_b128 v243, v[204:207] offset:11264
    ds_write_b128 v243, v[208:211] offset:12288
    ds_write_b128 v243, v[212:215] offset:13312
    ds_write_b128 v243, v[216:219] offset:14336
    ds_write_b128 v243, v[220:223] offset:15360
    v_mov_b32 v19, v17
    s_nop 1
    v_permlane16_swap_b32 v17, v19
    v_add_f32 v17, v17, v19
    v_mov_b32 v19, v17
    s_nop 1
    v_permlane32_swap_b32 v17, v19
    v_add_f32 v17, v17, v19
    v_mov_b32 v19, v18
    s_nop 1
    v_permlane16_swap_b32 v18, v19
    v_add_f32 v18, v18, v19
    v_mov_b32 v19, v18
    s_nop 1
    v_permlane32_swap_b32 v18, v19
    v_add_f32 v18, v18, v19
    s_lshl_b32 s94, s73, 8
    s_add_u32 s94, s94, 139264
    v_lshl_add_u32 v19, v1, 3, s94
    v_mov_b32 v28, v13
    v_mov_b32 v29, v17
    v_mov_b32 v30, v14
    v_mov_b32 v31, v18
    s_mov_b64 exec, 0xffff
    ds_write_b64 v19, v[28:29] offset:0
    ds_write_b64 v19, v[30:31] offset:128
    s_mov_b64 exec, -1
    s_cmp_ge_i32 s92, 0
    s_cbranch_scc1 L_bkls
L_bkl_backs:
    s_waitcnt vmcnt(0)
    s_cmp_lg_u32 s73, 0
    s_cbranch_scc1 L_tagdones
    v_readfirstlane_b32 s14, v232
    s_cmp_eq_u32 s14, 0
    s_cbranch_scc1 L_tagws
    s_nop 2
L_tagoks:
    v_mov_b32 v233, 0x2284c
    s_mov_b64 exec, 1
    ds_write_b32 v233, v232
    s_mov_b64 exec, -1
L_tagdones:
    s_lshr_b32 s98, s77, 1
    s_and_b32 s99, s77, 1
    v_and_b32 v20, 15, v1
    s_lshl_b32 s94, s76, 8
    s_lshl_b32 s95, s98, 7
    s_add_u32 s94, s94, s95
    s_add_u32 s94, s94, 139264
    v_lshl_add_u32 v20, v20, 3, s94
    s_lshl_b32 s94, s76, 14
    s_lshl_b32 s95, s77, 12
    s_add_u32 s94, s94, s95
    s_add_u32 s94, s94, 8192
    v_lshl_add_u32 v22, v1, 4, s94
    v_add_u32 v23, 0x10000, v22
    s_lshl_b32 s94, s2, 1
    s_add_u32 s94, s94, s98
    s_mul_i32 s94, s94, 16896
    s_add_u32 s94, s94, 0x140000
    s_lshl_b32 s96, s76, 6
    s_add_u32 s96, s96, s94
    s_add_u32 s96, s96, 0x1000
    s_lshl_b32 s97, s76, 11
    s_add_u32 s94, s94, s97
    s_lshl_b32 s97, s99, 10
    s_add_u32 s94, s94, s97
    v_mul_u32_u24 v21, 4224, v228
    v_lshl_add_u32 v21, v229, 4, v21
    v_lshl_add_u32 v21, v227, 6, v21
    v_mov_b32 v25, 0x22848
    s_waitcnt lgkmcnt(0)
    s_barrier
    ds_read_b32 v232, v25 offset:4
    ds_read_b32 v25, v25
    ds_read_b64 v[64:65], v20 offset:0
    ds_read_b64 v[66:67], v20 offset:512
    ds_read_b64 v[68:69], v20 offset:1024
    ds_read_b64 v[70:71], v20 offset:1536
    ds_read_b128 v[160:163], v22 offset:0
    ds_read_b128 v[176:179], v22 offset:32768
    ds_read_b128 v[192:195], v23 offset:0
    ds_read_b128 v[208:211], v23 offset:32768
    ds_read_b128 v[164:167], v22 offset:1024
    ds_read_b128 v[180:183], v22 offset:33792
    ds_read_b128 v[196:199], v23 offset:1024
    ds_read_b128 v[212:215], v23 offset:33792
    s_waitcnt lgkmcnt(8)
    v_mov_b32 v82, v232
    v_mov_b32 v83, v232
    v_cmp_ne_u32 vcc, 0, v25
    s_cbranch_vccnz L_general
    v_max3_f32 v80, v64, v66, v68
    v_max_f32 v80, v80, v70
    v_sub_f32 v84, v64, v80
    v_sub_f32 v85, v66, v80
    v_sub_f32 v86, v68, v80
    v_sub_f32 v87, v70, v80
    v_exp_f32 v84, v84
    v_exp_f32 v85, v85
    v_exp_f32 v86, v86
    v_exp_f32 v87, v87
    s_waitcnt lgkmcnt(4)
    ds_read_b128 v[168:171], v22 offset:2048
    ds_read_b128 v[184:187], v22 offset:34816
    ds_read_b128 v[200:203], v23 offset:2048
    ds_read_b128 v[216:219], v23 offset:34816
    s_waitcnt lgkmcnt(4)
    ds_read_b128 v[172:175], v22 offset:3072
    ds_read_b128 v[188:191], v22 offset:35840
    ds_read_b128 v[204:207], v23 offset:3072
    ds_read_b128 v[220:223], v23 offset:35840
    v_mul_f32 v160, v160, v84
    v_mul_f32 v161, v161, v84
    v_mul_f32 v162, v162, v84
    v_mul_f32 v163, v163, v84
    v_fmac_f32 v160, v176, v85
    v_fmac_f32 v161, v177, v85
    v_fmac_f32 v162, v178, v85
    v_fmac_f32 v163, v179, v85
    v_fmac_f32 v160, v192, v86
    v_fmac_f32 v161, v193, v86
    v_fmac_f32 v162, v194, v86
    v_fmac_f32 v163, v195, v86
    v_fmac_f32 v160, v208, v87
    v_fmac_f32 v161, v209, v87
    v_fmac_f32 v162, v210, v87
    v_fmac_f32 v163, v211, v87
    v_perm_b32 v160, v160, v232, s10
    v_perm_b32 v161, v161, v232, s11
    v_perm_b32 v162, v162, v232, s12
    v_perm_b32 v163, v163, v232, s13
    buffer_store_dwordx4 v[160:163], v21, s[44:47], s94 offen offset:0 sc1
    v_mul_f32 v164, v164, v84
    v_mul_f32 v165, v165, v84
    v_mul_f32 v166, v166, v84
    v_mul_f32 v167, v167, v84
    v_fmac_f32 v164, v180, v85
    v_fmac_f32 v165, v181, v85
    v_fmac_f32 v166, v182, v85
    v_fmac_f32 v167, v183, v85
    v_fmac_f32 v164, v196, v86
    v_fmac_f32 v165, v197, v86
    v_fmac_f32 v166, v198, v86
    v_fmac_f32 v167, v199, v86
    v_fmac_f32 v164, v212, v87
    v_fmac_f32 v165, v213, v87
    v_fmac_f32 v166, v214, v87
    v_fmac_f32 v167, v215, v87
    v_perm_b32 v164, v164, v232, s10
    v_perm_b32 v165, v165, v232, s11
    v_perm_b32 v166, v166, v232, s12
    v_perm_b32 v167, v167, v232, s13
    buffer_store_dwordx4 v[164:167], v21, s[44:47], s94 offen offset:256 sc1
    s_waitcnt lgkmcnt(4)
    v_mul_f32 v168, v168, v84
    v_mul_f32 v169, v169, v84
    v_mul_f32 v170, v170, v84
    v_mul_f32 v171, v171, v84
    v_fmac_f32 v168, v184, v85
    v_fmac_f32 v169, v185, v85
    v_fmac_f32 v170, v186, v85
    v_fmac_f32 v171, v187, v85
    v_fmac_f32 v168, v200, v86
    v_fmac_f32 v169, v201, v86
    v_fmac_f32 v170, v202, v86
    v_fmac_f32 v171, v203, v86
    v_fmac_f32 v168, v216, v87
    v_fmac_f32 v169, v217, v87
    v_fmac_f32 v170, v218, v87
    v_fmac_f32 v171, v219, v87
    v_perm_b32 v168, v168, v232, s10
    v_perm_b32 v169, v169, v232, s11
    v_perm_b32 v170, v170, v232, s12
    v_perm_b32 v171, v171, v232, s13
    buffer_store_dwordx4 v[168:171], v21, s[44:47], s94 offen offset:512 sc1
    s_waitcnt lgkmcnt(0)
    v_mul_f32 v172, v172, v84
    v_mul_f32 v173, v173, v84
    v_mul_f32 v174, v174, v84
    v_mul_f32 v175, v175, v84
    v_fmac_f32 v172, v188, v85
    v_fmac_f32 v173, v189, v85
    v_fmac_f32 v174, v190, v85
    v_fmac_f32 v175, v191, v85
    v_fmac_f32 v172, v204, v86
    v_fmac_f32 v173, v205, v86
    v_fmac_f32 v174, v206, v86
    v_fmac_f32 v175, v207, v86
    v_fmac_f32 v172, v220, v87
    v_fmac_f32 v173, v221, v87
    v_fmac_f32 v174, v222, v87
    v_fmac_f32 v175, v223, v87
    v_perm_b32 v172, v172, v232, s10
    v_perm_b32 v173, v173, v232, s11
    v_perm_b32 v174, v174, v232, s12
    v_perm_b32 v175, v175, v232, s13
    buffer_store_dwordx4 v[172:175], v21, s[44:47], s94 offen offset:768 sc1
    s_cmp_lg_u32 s99, 0
    s_cbranch_scc1 L_publish
    v_mul_f32 v81, v65, v84
    v_fmac_f32 v81, v67, v85
    v_fmac_f32 v81, v69, v86
    v_fmac_f32 v81, v71, v87
    s_mov_b64 exec, 0xffff
    buffer_store_dwordx4 v[80:83], v21, s[44:47], s96 offen sc1
    s_mov_b64 exec, -1
    s_branch L_publish
L_fonly:
    s_cmp_lg_u32 s78, 0
    s_cbranch_scc1 L_ver_6
    s_waitcnt vmcnt(0)
    s_waitcnt lgkmcnt(0)
    s_cmp_ge_u32 s73, 4
    s_cselect_b32 s94, 0x100, 0
    v_mov_b32 v233, v0
    v_xor_b32 v234, v233, v96
    v_add_u32 v233, s94, v233
    v_xor_b32 v235, v233, v97
    v_or_b32 v234, v234, v235
    v_add_u32 v233, s94, v233
    v_xor_b32 v235, v233, v98
    v_or_b32 v234, v234, v235
    v_add_u32 v233, s94, v233
    v_xor_b32 v235, v233, v99
    v_or_b32 v234, v234, v235
    v_add_u32 v233, s94, v233
    v_xor_b32 v235, v233, v100
    v_or_b32 v234, v234, v235
    v_add_u32 v233, s94, v233
    v_xor_b32 v235, v233, v101
    v_or_b32 v234, v234, v235
    v_add_u32 v233, s94, v233
    v_xor_b32 v235, v233, v102
    v_or_b32 v234, v234, v235
    v_add_u32 v233, s94, v233
    v_xor_b32 v235, v233, v103
    v_or_b32 v234, v234, v235
    s_xor_b32 s94, s48, 7759
    s_xor_b32 s95, s49, 7326
    s_or_b32 s94, s94, s95
    s_xor_b32 s95, s50, 6893
    s_or_b32 s94, s94, s95
    s_xor_b32 s95, s51, 6460
    s_or_b32 s94, s94, s95
    s_xor_b32 s95, s52, 8075
    s_or_b32 s94, s94, s95
    s_xor_b32 s95, s53, 7642
    s_or_b32 s94, s94, s95
    s_xor_b32 s95, s54, 7209
    s_or_b32 s94, s94, s95
    s_xor_b32 s95, s55, 6776
    s_or_b32 s94, s94, s95
    v_or_b32 v234, s94, v234
    v_cmp_ne_u32 vcc, 0, v234
    s_nop 3
    s_cbranch_vccz L_ver_6
    v_mov_b32 v233, 0x22840
    v_mov_b32 v234, 0x10000
    s_mov_b64 exec, 1
    ds_write_b32 v233, v234 offset:0
    ds_write_b32 v233, v234 offset:4
    ds_write_b32 v233, v234 offset:8
    s_mov_b64 exec, -1
    s_waitcnt lgkmcnt(0)
L_ver_6:
    v_mov_b32 v233, 0
    v_mov_b32 v234, 0
    v_writelane_b32 v233, s64, 0
    v_writelane_b32 v234, s56, 0
    v_writelane_b32 v233, s65, 1
    v_writelane_b32 v234, s57, 1
    v_writelane_b32 v233, s66, 2
    v_writelane_b32 v234, s58, 2
    v_writelane_b32 v233, s67, 3
    v_writelane_b32 v234, s59, 3
    v_writelane_b32 v233, s68, 4
    v_writelane_b32 v234, s60, 4
    v_writelane_b32 v233, s69, 5
    v_writelane_b32 v234, s61, 5
    v_writelane_b32 v233, s70, 6
    v_writelane_b32 v234, s62, 6
    v_writelane_b32 v233, s71, 7
    v_writelane_b32 v234, s63, 7
    v_cvt_f32_u32 v235, s72
    v_add_u32 v236, v233, v234
    v_add_u32 v237, 1, v233
    v_rcp_f32 v235, v235
    v_mul_lo_u32 v236, v236, s81
    v_mul_lo_u32 v237, v237, s81
    v_cvt_f32_u32 v236, v236
    v_cvt_f32_u32 v237, v237
    v_add_f32 v236, -0.5, v236
    v_add_f32 v237, -0.5, v237
    v_mul_f32 v236, v236, v235
    v_mul_f32 v237, v237, v235
    v_cvt_u32_f32 v236, v236
    v_cvt_u32_f32 v224, v237
    v_sub_u32 v238, v236, v224
    v_add_u32 v238, 1, v238
    v_cmp_lt_u32 vcc, 0, v234
    s_nop 1
    v_cndmask_b32 v225, 0, v238, vcc
    s_cmp_lg_u32 s78, 0
    s_cbranch_scc1 L_bkc_7
    v_writelane_b32 v224, 0, 0
    v_writelane_b32 v225, 8, 0
    v_writelane_b32 v224, 7, 1
    v_writelane_b32 v225, 7, 1
    v_writelane_b32 v224, 13, 2
    v_writelane_b32 v225, 7, 2
    v_writelane_b32 v224, 19, 3
    v_writelane_b32 v225, 5, 3
    v_writelane_b32 v224, 24, 4
    v_writelane_b32 v225, 9, 4
    v_writelane_b32 v224, 32, 5
    v_writelane_b32 v225, 8, 5
    v_writelane_b32 v224, 39, 6
    v_writelane_b32 v225, 7, 6
    v_writelane_b32 v224, 45, 7
    v_writelane_b32 v225, 6, 7
    s_nop 1
L_bkc_7:
    v_add_u32 v226, s80, v225
    v_sub_u32 v233, s90, v224
    v_cmp_lt_u32 vcc, v233, v225
    s_nop 0
    s_and_b32 s93, vcc_lo, 0xff
    s_ff1_i32_b32 s88, s93
    s_flbit_i32_b32 s89, s93
    s_sub_u32 s89, 31, s89
    s_mov_b32 s10, 0x07060500
    s_mov_b32 s11, 0x07060501
    s_mov_b32 s12, 0x07060502
    s_mov_b32 s13, 0x07060503
    s_mov_b32 s92, -1
    v_mov_b32 v21, 0x22848
    s_waitcnt vmcnt(0)
    s_cmp_lg_u32 s73, 0
    s_cbranch_scc1 L_tagdonef
    v_readfirstlane_b32 s14, v232
    s_cmp_eq_u32 s14, 0
    s_cbranch_scc1 L_tagwf
    s_nop 2
L_tagokf:
    v_mov_b32 v233, 0x2284c
    s_mov_b64 exec, 1
    ds_write_b32 v233, v232
    s_mov_b64 exec, -1
L_tagdonef:
    s_waitcnt lgkmcnt(0)
    s_barrier
    ds_read_b32 v232, v21 offset:4
    ds_read_b32 v21, v21
    s_waitcnt lgkmcnt(0)
L_publish:
    s_cmp_eq_u32 s0, 56
    s_cselect_b32 s94, 56, 0
    s_sub_u32 s87, s75, s94
    s_cmp_ge_u32 s87, 8
    s_cbranch_scc1 L_end
    s_waitcnt lgkmcnt(0)
    v_readlane_b32 s88, v224, s87
    v_readlane_b32 s89, v226, s87
    s_lshl_b32 s96, s74, 3
    s_add_u32 s96, s96, s87
    s_mul_i32 s96, s96, 4224
    s_add_u32 s96, s96, 0x140000
    s_add_u32 s97, s88, s87
    s_sub_u32 s97, s97, s80
    s_lshl_b32 s97, s97, 2
    s_add_u32 s97, s97, s74
    s_mul_i32 s97, s97, 4224
    v_and_b32 v2, 31, v1
    s_lshl_b32 s94, s73, 9
    v_lshl_add_u32 v4, v2, 4, s94
    s_lshr_b32 s98, s73, 2
    s_lshl_b32 s94, s98, 6
    s_add_u32 s94, s94, 0x1000
    v_lshl_add_u32 v5, v229, 4, s94
    v_lshrrev_b32 v3, 5, v1
    v_mov_b32 v6, 0xff7fffff
    v_mov_b32 v7, 0
    v_mov_b32 v8, 0
    v_mov_b32 v9, 0
    v_mov_b32 v10, 0
    v_mov_b32 v11, 0
    s_bfe_u32 s94, s73, 0x10001
    s_lshl_b32 s94, s94, 3
    s_lshl_b32 s95, s98, 10
    s_add_u32 s94, s94, s95
    s_lshl_b32 s95, s76, 2
    s_add_u32 s94, s94, s95
    v_lshl_add_u32 v16, v229, 8, s94
    v_and_b32 v12, 1, v227
    v_lshl_add_u32 v16, v12, 1, v16
    v_lshl_add_u32 v16, v3, 5, v16
    v_lshl_add_u32 v16, v228, 6, v16
    s_lshl_b32 s99, s87, 13
    s_lshl_b32 s95, s74, 11
    s_add_u32 s99, s99, s95
    s_mov_b32 s86, 0
    s_mov_b32 s85, 0
    s_mov_b32 s100, 0x0c0c0400
    s_mov_b32 s101, 0x04000c0c
    v_mov_b32 v17, 0xffffff00
    v_mov_b32 v18, v232
    v_mov_b32 v19, v232
    s_nop 1
L_pass:
    s_cmp_lt_u32 s85, s80
    s_cselect_b32 s15, s80, s89
    s_cselect_b32 s94, s96, s97
    s_mov_b32 s95, 16896
    s_cselect_b32 s95, 135168, s95
    s_add_u32 s98, s85, 14
    s_min_u32 s15, s15, s98
    v_add_u32 v12, s85, v3
    v_mul_lo_u32 v13, v12, s95
    v_add_u32 v13, s94, v13
    s_lshl_b32 s95, s95, 1
    v_cmp_gt_u32 s[48:49], s15, v12
    v_add_u32 v20, v13, v4
    v_add_u32 v27, v13, v5
    v_add_u32 v12, 2, v12
    v_add_u32 v13, s95, v13
    v_cmp_gt_u32 s[50:51], s15, v12
    v_add_u32 v21, v13, v4
    v_add_u32 v28, v13, v5
    v_add_u32 v12, 2, v12
    v_add_u32 v13, s95, v13
    v_cmp_gt_u32 s[52:53], s15, v12
    v_add_u32 v22, v13, v4
    v_add_u32 v29, v13, v5
    v_add_u32 v12, 2, v12
    v_add_u32 v13, s95, v13
    v_cmp_gt_u32 s[54:55], s15, v12
    v_add_u32 v23, v13, v4
    v_add_u32 v30, v13, v5
    v_add_u32 v12, 2, v12
    v_add_u32 v13, s95, v13
    v_cmp_gt_u32 s[56:57], s15, v12
    v_add_u32 v24, v13, v4
    v_add_u32 v31, v13, v5
    v_add_u32 v12, 2, v12
    v_add_u32 v13, s95, v13
    v_cmp_gt_u32 s[58:59], s15, v12
    v_add_u32 v25, v13, v4
    v_add_u32 v32, v13, v5
    v_add_u32 v12, 2, v12
    v_add_u32 v13, s95, v13
    v_cmp_gt_u32 s[60:61], s15, v12
    v_add_u32 v26, v13, v4
    v_add_u32 v33, v13, v5
    s_mov_b32 s12, s58
    s_nop 1
L_wait:
    s_mov_b64 exec, s[48:49]
    buffer_load_dwordx3 v[124:126], v27, s[44:47], 0 offen sc1
    s_add_u32 s86, s86, 1
    s_waitcnt vmcnt(0)
    v_cmp_eq_u32 vcc, v232, v126
    s_mov_b64 exec, -1
    s_nop 2
    s_cbranch_vccnz L_round
    s_cmp_lt_u32 s86, 0x20000
    s_cbranch_scc1 L_wait
L_round:
    s_mov_b64 exec, s[48:49]
    s_cbranch_execz L_rl0
    buffer_load_dwordx4 v[96:99], v20, s[44:47], 0 offen sc1
    buffer_load_dwordx3 v[124:126], v27, s[44:47], 0 offen sc1
L_rl0:
    s_mov_b64 exec, s[50:51]
    s_cbranch_execz L_rl1
    buffer_load_dwordx4 v[100:103], v21, s[44:47], 0 offen sc1
    buffer_load_dwordx3 v[128:130], v28, s[44:47], 0 offen sc1
L_rl1:
    s_mov_b64 exec, s[52:53]
    s_cbranch_execz L_rl2
    buffer_load_dwordx4 v[104:107], v22, s[44:47], 0 offen sc1
    buffer_load_dwordx3 v[132:134], v29, s[44:47], 0 offen sc1
L_rl2:
    s_mov_b64 exec, s[54:55]
    s_cbranch_execz L_rl3
    buffer_load_dwordx4 v[108:111], v23, s[44:47], 0 offen sc1
    buffer_load_dwordx3 v[136:138], v30, s[44:47], 0 offen sc1
L_rl3:
    s_mov_b64 exec, s[56:57]
    s_cbranch_execz L_rl4
    buffer_load_dwordx4 v[112:115], v24, s[44:47], 0 offen sc1
    buffer_load_dwordx3 v[140:142], v31, s[44:47], 0 offen sc1
L_rl4:
    s_cmp_eq_u32 s12, 0
    s_cbranch_scc1 L_rl6
    s_mov_b64 exec, s[58:59]
    s_cbranch_execz L_rl5
    buffer_load_dwordx4 v[116:119], v25, s[44:47], 0 offen sc1
    buffer_load_dwordx3 v[144:146], v32, s[44:47], 0 offen sc1
L_rl5:
    s_mov_b64 exec, s[60:61]
    s_cbranch_execz L_rl6
    buffer_load_dwordx4 v[120:123], v26, s[44:47], 0 offen sc1
    buffer_load_dwordx3 v[148:150], v33, s[44:47], 0 offen sc1
L_rl6:
    s_add_u32 s86, s86, 1
    s_mov_b64 s[10:11], 0
    s_waitcnt vmcnt(0)
    s_mov_b64 exec, s[48:49]
    s_cbranch_execz L_rsa0
    v_perm_b32 v12, v97, v96, s100
    v_perm_b32 v13, v99, v98, s101
    v_or_b32 v127, v12, v13
    v_cmpx_eq_u64 vcc, v[126:127], v[18:19]
    v_max_f32 v12, v6, v124
    s_andn2_b64 s[48:49], s[48:49], vcc
    s_or_b64 s[10:11], s[10:11], s[48:49]
    s_cbranch_execz L_rsa0
    v_sub_f32 v13, v6, v12
    v_sub_f32 v14, v124, v12
    v_exp_f32 v13, v13
    v_exp_f32 v14, v14
    v_and_b32 v96, v17, v96
    v_and_b32 v97, v17, v97
    v_and_b32 v98, v17, v98
    v_and_b32 v99, v17, v99
    v_mov_b32 v6, v12
    v_mul_f32 v7, v7, v13
    v_mul_f32 v8, v8, v13
    v_mul_f32 v9, v9, v13
    v_mul_f32 v10, v10, v13
    v_mul_f32 v11, v11, v13
    v_fmac_f32 v7, v125, v14
    v_fmac_f32 v8, v96, v14
    v_fmac_f32 v9, v97, v14
    v_fmac_f32 v10, v98, v14
    v_fmac_f32 v11, v99, v14
L_rsa0:
    s_mov_b64 exec, s[50:51]
    s_cbranch_execz L_rsa1
    v_perm_b32 v12, v101, v100, s100
    v_perm_b32 v13, v103, v102, s101
    v_or_b32 v131, v12, v13
    v_cmpx_eq_u64 vcc, v[130:131], v[18:19]
    v_max_f32 v12, v6, v128
    s_andn2_b64 s[50:51], s[50:51], vcc
    s_or_b64 s[10:11], s[10:11], s[50:51]
    s_cbranch_execz L_rsa1
    v_sub_f32 v13, v6, v12
    v_sub_f32 v14, v128, v12
    v_exp_f32 v13, v13
    v_exp_f32 v14, v14
    v_and_b32 v100, v17, v100
    v_and_b32 v101, v17, v101
    v_and_b32 v102, v17, v102
    v_and_b32 v103, v17, v103
    v_mov_b32 v6, v12
    v_mul_f32 v7, v7, v13
    v_mul_f32 v8, v8, v13
    v_mul_f32 v9, v9, v13
    v_mul_f32 v10, v10, v13
    v_mul_f32 v11, v11, v13
    v_fmac_f32 v7, v129, v14
    v_fmac_f32 v8, v100, v14
    v_fmac_f32 v9, v101, v14
    v_fmac_f32 v10, v102, v14
    v_fmac_f32 v11, v103, v14
L_rsa1:
    s_mov_b64 exec, s[52:53]
    s_cbranch_execz L_rsa2
    v_perm_b32 v12, v105, v104, s100
    v_perm_b32 v13, v107, v106, s101
    v_or_b32 v135, v12, v13
    v_cmpx_eq_u64 vcc, v[134:135], v[18:19]
    v_max_f32 v12, v6, v132
    s_andn2_b64 s[52:53], s[52:53], vcc
    s_or_b64 s[10:11], s[10:11], s[52:53]
    s_cbranch_execz L_rsa2
    v_sub_f32 v13, v6, v12
    v_sub_f32 v14, v132, v12
    v_exp_f32 v13, v13
    v_exp_f32 v14, v14
    v_and_b32 v104, v17, v104
    v_and_b32 v105, v17, v105
    v_and_b32 v106, v17, v106
    v_and_b32 v107, v17, v107
    v_mov_b32 v6, v12
    v_mul_f32 v7, v7, v13
    v_mul_f32 v8, v8, v13
    v_mul_f32 v9, v9, v13
    v_mul_f32 v10, v10, v13
    v_mul_f32 v11, v11, v13
    v_fmac_f32 v7, v133, v14
    v_fmac_f32 v8, v104, v14
    v_fmac_f32 v9, v105, v14
    v_fmac_f32 v10, v106, v14
    v_fmac_f32 v11, v107, v14
L_rsa2:
    s_mov_b64 exec, s[54:55]
    s_cbranch_execz L_rsa3
    v_perm_b32 v12, v109, v108, s100
    v_perm_b32 v13, v111, v110, s101
    v_or_b32 v139, v12, v13
    v_cmpx_eq_u64 vcc, v[138:139], v[18:19]
    v_max_f32 v12, v6, v136
    s_andn2_b64 s[54:55], s[54:55], vcc
    s_or_b64 s[10:11], s[10:11], s[54:55]
    s_cbranch_execz L_rsa3
    v_sub_f32 v13, v6, v12
    v_sub_f32 v14, v136, v12
    v_exp_f32 v13, v13
    v_exp_f32 v14, v14
    v_and_b32 v108, v17, v108
    v_and_b32 v109, v17, v109
    v_and_b32 v110, v17, v110
    v_and_b32 v111, v17, v111
    v_mov_b32 v6, v12
    v_mul_f32 v7, v7, v13
    v_mul_f32 v8, v8, v13
    v_mul_f32 v9, v9, v13
    v_mul_f32 v10, v10, v13
    v_mul_f32 v11, v11, v13
    v_fmac_f32 v7, v137, v14
    v_fmac_f32 v8, v108, v14
    v_fmac_f32 v9, v109, v14
    v_fmac_f32 v10, v110, v14
    v_fmac_f32 v11, v111, v14
L_rsa3:
    s_mov_b64 exec, s[56:57]
    s_cbranch_execz L_rsa4
    v_perm_b32 v12, v113, v112, s100
    v_perm_b32 v13, v115, v114, s101
    v_or_b32 v143, v12, v13
    v_cmpx_eq_u64 vcc, v[142:143], v[18:19]
    v_max_f32 v12, v6, v140
    s_andn2_b64 s[56:57], s[56:57], vcc
    s_or_b64 s[10:11], s[10:11], s[56:57]
    s_cbranch_execz L_rsa4
    v_sub_f32 v13, v6, v12
    v_sub_f32 v14, v140, v12
    v_exp_f32 v13, v13
    v_exp_f32 v14, v14
    v_and_b32 v112, v17, v112
    v_and_b32 v113, v17, v113
    v_and_b32 v114, v17, v114
    v_and_b32 v115, v17, v115
    v_mov_b32 v6, v12
    v_mul_f32 v7, v7, v13
    v_mul_f32 v8, v8, v13
    v_mul_f32 v9, v9, v13
    v_mul_f32 v10, v10, v13
    v_mul_f32 v11, v11, v13
    v_fmac_f32 v7, v141, v14
    v_fmac_f32 v8, v112, v14
    v_fmac_f32 v9, v113, v14
    v_fmac_f32 v10, v114, v14
    v_fmac_f32 v11, v115, v14
L_rsa4:
    s_cmp_eq_u32 s12, 0
    s_cbranch_scc1 L_rsa6
    s_mov_b64 exec, s[58:59]
    s_cbranch_execz L_rsa5
    v_perm_b32 v12, v117, v116, s100
    v_perm_b32 v13, v119, v118, s101
    v_or_b32 v147, v12, v13
    v_cmpx_eq_u64 vcc, v[146:147], v[18:19]
    v_max_f32 v12, v6, v144
    s_andn2_b64 s[58:59], s[58:59], vcc
    s_or_b64 s[10:11], s[10:11], s[58:59]
    s_cbranch_execz L_rsa5
    v_sub_f32 v13, v6, v12
    v_sub_f32 v14, v144, v12
    v_exp_f32 v13, v13
    v_exp_f32 v14, v14
    v_and_b32 v116, v17, v116
    v_and_b32 v117, v17, v117
    v_and_b32 v118, v17, v118
    v_and_b32 v119, v17, v119
    v_mov_b32 v6, v12
    v_mul_f32 v7, v7, v13
    v_mul_f32 v8, v8, v13
    v_mul_f32 v9, v9, v13
    v_mul_f32 v10, v10, v13
    v_mul_f32 v11, v11, v13
    v_fmac_f32 v7, v145, v14
    v_fmac_f32 v8, v116, v14
    v_fmac_f32 v9, v117, v14
    v_fmac_f32 v10, v118, v14
    v_fmac_f32 v11, v119, v14
L_rsa5:
    s_mov_b64 exec, s[60:61]
    s_cbranch_execz L_rsa6
    v_perm_b32 v12, v121, v120, s100
    v_perm_b32 v13, v123, v122, s101
    v_or_b32 v151, v12, v13
    v_cmpx_eq_u64 vcc, v[150:151], v[18:19]
    v_max_f32 v12, v6, v148
    s_andn2_b64 s[60:61], s[60:61], vcc
    s_or_b64 s[10:11], s[10:11], s[60:61]
    s_cbranch_execz L_rsa6
    v_sub_f32 v13, v6, v12
    v_sub_f32 v14, v148, v12
    v_exp_f32 v13, v13
    v_exp_f32 v14, v14
    v_and_b32 v120, v17, v120
    v_and_b32 v121, v17, v121
    v_and_b32 v122, v17, v122
    v_and_b32 v123, v17, v123
    v_mov_b32 v6, v12
    v_mul_f32 v7, v7, v13
    v_mul_f32 v8, v8, v13
    v_mul_f32 v9, v9, v13
    v_mul_f32 v10, v10, v13
    v_mul_f32 v11, v11, v13
    v_fmac_f32 v7, v149, v14
    v_fmac_f32 v8, v120, v14
    v_fmac_f32 v9, v121, v14
    v_fmac_f32 v10, v122, v14
    v_fmac_f32 v11, v123, v14
L_rsa6:
    s_mov_b64 exec, -1
    s_cmp_eq_u64 s[10:11], 0
    s_cbranch_scc1 L_passdone
    s_cmp_lt_u32 s86, 0x20000
    s_cbranch_scc1 L_round
L_passdone:
    v_mov_b32 v12, v6
    v_mov_b32 v13, v7
    s_mov_b32 s85, s15
    s_cmp_lt_u32 s85, s89
    s_cbranch_scc1 L_pass
    v_permlane32_swap_b32 v6, v12
    v_permlane32_swap_b32 v7, v13
    v_permlane32_swap_b32 v8, v10
    v_permlane32_swap_b32 v9, v11
    v_max_f32 v14, v6, v12
    v_sub_f32 v6, v6, v14
    v_sub_f32 v12, v12, v14
    v_exp_f32 v6, v6
    v_exp_f32 v12, v12
    v_mul_f32 v7, v7, v6
    v_fmac_f32 v7, v13, v12
    v_rcp_f32 v7, v7
    v_mul_f32 v8, v8, v6
    v_mul_f32 v9, v9, v6
    v_fmac_f32 v8, v10, v12
    v_fmac_f32 v9, v11, v12
    v_mul_f32 v8, v8, v7
    v_mul_f32 v9, v9, v7
    v_cvt_pk_bf16_f32 v14, v8, v9
    buffer_store_short v14, v16, s[36:39], s99 offen
    buffer_store_short_d16_hi v14, v16, s[36:39], s99 offen offset:16
L_end:
L_exit:
    s_endpgm
L_earlys:
    s_cmp_eq_u32 s16, 0
    s_cbranch_scc1 L_early0s
    s_cmp_lg_u32 s73, 0
    s_cbranch_scc1 L_notls
    buffer_load_dword v232, off, s[40:43], 0 sc1
    s_branch L_notls
L_early0s:
    s_branch L_notls
L_bks:
    s_nop 7
    s_cmp_lg_u32 s78, 0
    s_cbranch_scc1 L_ver_8
    s_waitcnt lgkmcnt(0)
    s_cmp_ge_u32 s73, 4
    s_cselect_b32 s94, 0x100, 0
    v_mov_b32 v233, v0
    v_xor_b32 v234, v233, v96
    v_add_u32 v233, s94, v233
    v_xor_b32 v235, v233, v97
    v_or_b32 v234, v234, v235
    v_add_u32 v233, s94, v233
    v_xor_b32 v235, v233, v98
    v_or_b32 v234, v234, v235
    v_add_u32 v233, s94, v233
    v_xor_b32 v235, v233, v99
    v_or_b32 v234, v234, v235
    v_add_u32 v233, s94, v233
    v_xor_b32 v235, v233, v100
    v_or_b32 v234, v234, v235
    v_add_u32 v233, s94, v233
    v_xor_b32 v235, v233, v101
    v_or_b32 v234, v234, v235
    v_add_u32 v233, s94, v233
    v_xor_b32 v235, v233, v102
    v_or_b32 v234, v234, v235
    v_add_u32 v233, s94, v233
    v_xor_b32 v235, v233, v103
    v_or_b32 v234, v234, v235
    s_xor_b32 s94, s48, 7759
    s_xor_b32 s95, s49, 7326
    s_or_b32 s94, s94, s95
    s_xor_b32 s95, s50, 6893
    s_or_b32 s94, s94, s95
    s_xor_b32 s95, s51, 6460
    s_or_b32 s94, s94, s95
    s_xor_b32 s95, s52, 8075
    s_or_b32 s94, s94, s95
    s_xor_b32 s95, s53, 7642
    s_or_b32 s94, s94, s95
    s_xor_b32 s95, s54, 7209
    s_or_b32 s94, s94, s95
    s_xor_b32 s95, s55, 6776
    s_or_b32 s94, s94, s95
    v_or_b32 v234, s94, v234
    v_cmp_ne_u32 vcc, 0, v234
    s_nop 3
    s_cbranch_vccz L_ver_8
    v_mov_b32 v233, 0x22840
    v_mov_b32 v234, 0x10000
    s_mov_b64 exec, 1
    ds_write_b32 v233, v234 offset:0
    ds_write_b32 v233, v234 offset:4
    ds_write_b32 v233, v234 offset:8
    s_mov_b64 exec, -1
    s_waitcnt lgkmcnt(0)
L_ver_8:
    v_mov_b32 v233, 0
    v_mov_b32 v234, 0
    v_writelane_b32 v233, s64, 0
    v_writelane_b32 v234, s56, 0
    v_writelane_b32 v233, s65, 1
    v_writelane_b32 v234, s57, 1
    v_writelane_b32 v233, s66, 2
    v_writelane_b32 v234, s58, 2
    v_writelane_b32 v233, s67, 3
    v_writelane_b32 v234, s59, 3
    v_writelane_b32 v233, s68, 4
    v_writelane_b32 v234, s60, 4
    v_writelane_b32 v233, s69, 5
    v_writelane_b32 v234, s61, 5
    v_writelane_b32 v233, s70, 6
    v_writelane_b32 v234, s62, 6
    v_writelane_b32 v233, s71, 7
    v_writelane_b32 v234, s63, 7
    v_cvt_f32_u32 v235, s72
    v_add_u32 v236, v233, v234
    v_add_u32 v237, 1, v233
    v_rcp_f32 v235, v235
    v_mul_lo_u32 v236, v236, s81
    v_mul_lo_u32 v237, v237, s81
    v_cvt_f32_u32 v236, v236
    v_cvt_f32_u32 v237, v237
    v_add_f32 v236, -0.5, v236
    v_add_f32 v237, -0.5, v237
    v_mul_f32 v236, v236, v235
    v_mul_f32 v237, v237, v235
    v_cvt_u32_f32 v236, v236
    v_cvt_u32_f32 v224, v237
    v_sub_u32 v238, v236, v224
    v_add_u32 v238, 1, v238
    v_cmp_lt_u32 vcc, 0, v234
    s_nop 1
    v_cndmask_b32 v225, 0, v238, vcc
    s_cmp_lg_u32 s78, 0
    s_cbranch_scc1 L_bkc_9
    v_writelane_b32 v224, 0, 0
    v_writelane_b32 v225, 8, 0
    v_writelane_b32 v224, 7, 1
    v_writelane_b32 v225, 7, 1
    v_writelane_b32 v224, 13, 2
    v_writelane_b32 v225, 7, 2
    v_writelane_b32 v224, 19, 3
    v_writelane_b32 v225, 5, 3
    v_writelane_b32 v224, 24, 4
    v_writelane_b32 v225, 9, 4
    v_writelane_b32 v224, 32, 5
    v_writelane_b32 v225, 8, 5
    v_writelane_b32 v224, 39, 6
    v_writelane_b32 v225, 7, 6
    v_writelane_b32 v224, 45, 7
    v_writelane_b32 v225, 6, 7
    s_nop 1
L_bkc_9:
    v_add_u32 v226, s80, v225
    v_sub_u32 v233, s90, v224
    v_cmp_lt_u32 vcc, v233, v225
    s_nop 0
    s_and_b32 s93, vcc_lo, 0xff
    s_ff1_i32_b32 s88, s93
    s_flbit_i32_b32 s89, s93
    s_sub_u32 s89, 31, s89
    s_mov_b32 s10, 0x07060500
    s_mov_b32 s11, 0x07060501
    s_mov_b32 s12, 0x07060502
    s_mov_b32 s13, 0x07060503
    s_mov_b32 s92, -1
    s_branch L_bk_backs
L_smask:
    s_nop 7
    s_add_u32 s94, s6, 0
    v_cmp_lt_i32 vcc, s94, v11
    s_nop 1
    v_cndmask_b32 v28, v230, v28, vcc
    v_cmp_lt_i32 vcc, s94, v12
    s_nop 1
    v_cndmask_b32 v32, v230, v32, vcc
    s_add_u32 s94, s6, 1
    v_cmp_lt_i32 vcc, s94, v11
    s_nop 1
    v_cndmask_b32 v29, v230, v29, vcc
    v_cmp_lt_i32 vcc, s94, v12
    s_nop 1
    v_cndmask_b32 v33, v230, v33, vcc
    s_add_u32 s94, s6, 2
    v_cmp_lt_i32 vcc, s94, v11
    s_nop 1
    v_cndmask_b32 v30, v230, v30, vcc
    v_cmp_lt_i32 vcc, s94, v12
    s_nop 1
    v_cndmask_b32 v34, v230, v34, vcc
    s_add_u32 s94, s6, 3
    v_cmp_lt_i32 vcc, s94, v11
    s_nop 1
    v_cndmask_b32 v31, v230, v31, vcc
    v_cmp_lt_i32 vcc, s94, v12
    s_nop 1
    v_cndmask_b32 v35, v230, v35, vcc
    s_nop 0
    s_branch L_smask_back
L_sresc:
    s_nop 7
    v_mov_b32 v21, v19
    s_nop 1
    v_permlane16_swap_b32 v19, v21
    v_max_f32 v19, v19, v21
    v_mov_b32 v21, v19
    s_nop 1
    v_permlane32_swap_b32 v19, v21
    v_max_f32 v19, v19, v21
    v_max_f32 v19, v19, v13
    v_sub_f32 v21, v13, v19
    v_exp_f32 v21, v21
    v_mov_b32 v13, v19
    v_add_f32 v15, 0x41000000, v19
    v_mul_f32 v17, v17, v21
    v_mul_f32 v160, v160, v21
    v_mul_f32 v161, v161, v21
    v_mul_f32 v162, v162, v21
    v_mul_f32 v163, v163, v21
    v_mul_f32 v164, v164, v21
    v_mul_f32 v165, v165, v21
    v_mul_f32 v166, v166, v21
    v_mul_f32 v167, v167, v21
    v_mul_f32 v168, v168, v21
    v_mul_f32 v169, v169, v21
    v_mul_f32 v170, v170, v21
    v_mul_f32 v171, v171, v21
    v_mul_f32 v172, v172, v21
    v_mul_f32 v173, v173, v21
    v_mul_f32 v174, v174, v21
    v_mul_f32 v175, v175, v21
    v_mul_f32 v176, v176, v21
    v_mul_f32 v177, v177, v21
    v_mul_f32 v178, v178, v21
    v_mul_f32 v179, v179, v21
    v_mul_f32 v180, v180, v21
    v_mul_f32 v181, v181, v21
    v_mul_f32 v182, v182, v21
    v_mul_f32 v183, v183, v21
    v_mul_f32 v184, v184, v21
    v_mul_f32 v185, v185, v21
    v_mul_f32 v186, v186, v21
    v_mul_f32 v187, v187, v21
    v_mul_f32 v188, v188, v21
    v_mul_f32 v189, v189, v21
    v_mul_f32 v190, v190, v21
    v_mul_f32 v191, v191, v21
    v_mov_b32 v21, v20
    s_nop 1
    v_permlane16_swap_b32 v20, v21
    v_max_f32 v20, v20, v21
    v_mov_b32 v21, v20
    s_nop 1
    v_permlane32_swap_b32 v20, v21
    v_max_f32 v20, v20, v21
    v_max_f32 v20, v20, v14
    v_sub_f32 v21, v14, v20
    v_exp_f32 v21, v21
    v_mov_b32 v14, v20
    v_add_f32 v16, 0x41000000, v20
    v_mul_f32 v18, v18, v21
    v_mul_f32 v192, v192, v21
    v_mul_f32 v193, v193, v21
    v_mul_f32 v194, v194, v21
    v_mul_f32 v195, v195, v21
    v_mul_f32 v196, v196, v21
    v_mul_f32 v197, v197, v21
    v_mul_f32 v198, v198, v21
    v_mul_f32 v199, v199, v21
    v_mul_f32 v200, v200, v21
    v_mul_f32 v201, v201, v21
    v_mul_f32 v202, v202, v21
    v_mul_f32 v203, v203, v21
    v_mul_f32 v204, v204, v21
    v_mul_f32 v205, v205, v21
    v_mul_f32 v206, v206, v21
    v_mul_f32 v207, v207, v21
    v_mul_f32 v208, v208, v21
    v_mul_f32 v209, v209, v21
    v_mul_f32 v210, v210, v21
    v_mul_f32 v211, v211, v21
    v_mul_f32 v212, v212, v21
    v_mul_f32 v213, v213, v21
    v_mul_f32 v214, v214, v21
    v_mul_f32 v215, v215, v21
    v_mul_f32 v216, v216, v21
    v_mul_f32 v217, v217, v21
    v_mul_f32 v218, v218, v21
    v_mul_f32 v219, v219, v21
    v_mul_f32 v220, v220, v21
    v_mul_f32 v221, v221, v21
    v_mul_f32 v222, v222, v21
    v_mul_f32 v223, v223, v21
    s_nop 0
    s_branch L_sresc_back
L_bkls:
    s_nop 7
    s_cmp_lg_u32 s78, 0
    s_cbranch_scc1 L_ver_10
    s_waitcnt vmcnt(0)
    s_waitcnt lgkmcnt(0)
    s_cmp_ge_u32 s73, 4
    s_cselect_b32 s94, 0x100, 0
    v_mov_b32 v233, v0
    v_xor_b32 v234, v233, v96
    v_add_u32 v233, s94, v233
    v_xor_b32 v235, v233, v97
    v_or_b32 v234, v234, v235
    v_add_u32 v233, s94, v233
    v_xor_b32 v235, v233, v98
    v_or_b32 v234, v234, v235
    v_add_u32 v233, s94, v233
    v_xor_b32 v235, v233, v99
    v_or_b32 v234, v234, v235
    v_add_u32 v233, s94, v233
    v_xor_b32 v235, v233, v100
    v_or_b32 v234, v234, v235
    v_add_u32 v233, s94, v233
    v_xor_b32 v235, v233, v101
    v_or_b32 v234, v234, v235
    v_add_u32 v233, s94, v233
    v_xor_b32 v235, v233, v102
    v_or_b32 v234, v234, v235
    v_add_u32 v233, s94, v233
    v_xor_b32 v235, v233, v103
    v_or_b32 v234, v234, v235
    s_xor_b32 s94, s48, 7759
    s_xor_b32 s95, s49, 7326
    s_or_b32 s94, s94, s95
    s_xor_b32 s95, s50, 6893
    s_or_b32 s94, s94, s95
    s_xor_b32 s95, s51, 6460
    s_or_b32 s94, s94, s95
    s_xor_b32 s95, s52, 8075
    s_or_b32 s94, s94, s95
    s_xor_b32 s95, s53, 7642
    s_or_b32 s94, s94, s95
    s_xor_b32 s95, s54, 7209
    s_or_b32 s94, s94, s95
    s_xor_b32 s95, s55, 6776
    s_or_b32 s94, s94, s95
    v_or_b32 v234, s94, v234
    v_cmp_ne_u32 vcc, 0, v234
    s_nop 3
    s_cbranch_vccz L_ver_10
    v_mov_b32 v233, 0x22840
    v_mov_b32 v234, 0x10000
    s_mov_b64 exec, 1
    ds_write_b32 v233, v234 offset:0
    ds_write_b32 v233, v234 offset:4
    ds_write_b32 v233, v234 offset:8
    s_mov_b64 exec, -1
    s_waitcnt lgkmcnt(0)
L_ver_10:
    v_mov_b32 v233, 0
    v_mov_b32 v234, 0
    v_writelane_b32 v233, s64, 0
    v_writelane_b32 v234, s56, 0
    v_writelane_b32 v233, s65, 1
    v_writelane_b32 v234, s57, 1
    v_writelane_b32 v233, s66, 2
    v_writelane_b32 v234, s58, 2
    v_writelane_b32 v233, s67, 3
    v_writelane_b32 v234, s59, 3
    v_writelane_b32 v233, s68, 4
    v_writelane_b32 v234, s60, 4
    v_writelane_b32 v233, s69, 5
    v_writelane_b32 v234, s61, 5
    v_writelane_b32 v233, s70, 6
    v_writelane_b32 v234, s62, 6
    v_writelane_b32 v233, s71, 7
    v_writelane_b32 v234, s63, 7
    v_cvt_f32_u32 v235, s72
    v_add_u32 v236, v233, v234
    v_add_u32 v237, 1, v233
    v_rcp_f32 v235, v235
    v_mul_lo_u32 v236, v236, s81
    v_mul_lo_u32 v237, v237, s81
    v_cvt_f32_u32 v236, v236
    v_cvt_f32_u32 v237, v237
    v_add_f32 v236, -0.5, v236
    v_add_f32 v237, -0.5, v237
    v_mul_f32 v236, v236, v235
    v_mul_f32 v237, v237, v235
    v_cvt_u32_f32 v236, v236
    v_cvt_u32_f32 v224, v237
    v_sub_u32 v238, v236, v224
    v_add_u32 v238, 1, v238
    v_cmp_lt_u32 vcc, 0, v234
    s_nop 1
    v_cndmask_b32 v225, 0, v238, vcc
    s_cmp_lg_u32 s78, 0
    s_cbranch_scc1 L_bkc_11
    v_writelane_b32 v224, 0, 0
    v_writelane_b32 v225, 8, 0
    v_writelane_b32 v224, 7, 1
    v_writelane_b32 v225, 7, 1
    v_writelane_b32 v224, 13, 2
    v_writelane_b32 v225, 7, 2
    v_writelane_b32 v224, 19, 3
    v_writelane_b32 v225, 5, 3
    v_writelane_b32 v224, 24, 4
    v_writelane_b32 v225, 9, 4
    v_writelane_b32 v224, 32, 5
    v_writelane_b32 v225, 8, 5
    v_writelane_b32 v224, 39, 6
    v_writelane_b32 v225, 7, 6
    v_writelane_b32 v224, 45, 7
    v_writelane_b32 v225, 6, 7
    s_nop 1
L_bkc_11:
    v_add_u32 v226, s80, v225
    v_sub_u32 v233, s90, v224
    v_cmp_lt_u32 vcc, v233, v225
    s_nop 0
    s_and_b32 s93, vcc_lo, 0xff
    s_ff1_i32_b32 s88, s93
    s_flbit_i32_b32 s89, s93
    s_sub_u32 s89, 31, s89
    s_mov_b32 s10, 0x07060500
    s_mov_b32 s11, 0x07060501
    s_mov_b32 s12, 0x07060502
    s_mov_b32 s13, 0x07060503
    s_mov_b32 s92, -1
    s_branch L_bkl_backs
L_tagws:
    s_nop 7
    s_mov_b32 s101, 0
L_tagw2s:
    buffer_load_dword v232, off, s[40:43], 0 sc1
    s_add_u32 s101, s101, 1
    s_waitcnt vmcnt(0)
    v_readfirstlane_b32 s14, v232
    s_cmp_lg_u32 s14, 0
    s_nop 2
    s_cbranch_scc1 L_tagoks
    s_cmp_lt_u32 s101, 0x20000
    s_cbranch_scc1 L_tagw2s
    s_branch L_tagoks
L_tagwf:
    s_nop 7
    s_mov_b32 s101, 0
L_tagw2f:
    buffer_load_dword v232, off, s[40:43], 0 sc1
    s_add_u32 s101, s101, 1
    s_waitcnt vmcnt(0)
    v_readfirstlane_b32 s14, v232
    s_cmp_lg_u32 s14, 0
    s_nop 2
    s_cbranch_scc1 L_tagokf
    s_cmp_lt_u32 s101, 0x20000
    s_cbranch_scc1 L_tagw2f
    s_branch L_tagokf
L_general:
    s_nop 7
    s_waitcnt vmcnt(0) lgkmcnt(0)
    s_barrier
    s_cmp_lg_u32 s73, 7
    s_cbranch_scc1 L_general2
    v_mov_b32 v124, 0x22840
    v_mov_b32 v126, 4
    v_mov_b32 v127, 4
    v_mov_b32 v125, 0
    s_mov_b64 exec, 1
    ds_write_b64 v124, v[126:127]
    ds_write_b32 v124, v125 offset:8
    s_mov_b64 exec, -1
L_general2:
    s_mov_b32 s78, 1
    v_lshlrev_b32 v23, 4, v0
    s_lshl2_add_u32 s94, s73, 0x22800
    v_mov_b32 v25, s94
    v_mov_b32 v26, 0x22800
    s_waitcnt lgkmcnt(0)
    s_min_i32 s48, s48, 0x2000
    s_max_i32 s48, s48, 0
    s_add_u32 s94, s48, 15
    s_lshr_b32 s94, s94, 4
    s_cmp_lt_i32 s48, 1
    s_cselect_b32 s56, 0x200, s94
    s_min_i32 s49, s49, 0x2000
    s_max_i32 s49, s49, 0
    s_add_u32 s94, s49, 15
    s_lshr_b32 s94, s94, 4
    s_cmp_lt_i32 s49, 1
    s_cselect_b32 s57, 0x200, s94
    s_min_i32 s50, s50, 0x2000
    s_max_i32 s50, s50, 0
    s_add_u32 s94, s50, 15
    s_lshr_b32 s94, s94, 4
    s_cmp_lt_i32 s50, 1
    s_cselect_b32 s58, 0x200, s94
    s_min_i32 s51, s51, 0x2000
    s_max_i32 s51, s51, 0
    s_add_u32 s94, s51, 15
    s_lshr_b32 s94, s94, 4
    s_cmp_lt_i32 s51, 1
    s_cselect_b32 s59, 0x200, s94
    s_min_i32 s52, s52, 0x2000
    s_max_i32 s52, s52, 0
    s_add_u32 s94, s52, 15
    s_lshr_b32 s94, s94, 4
    s_cmp_lt_i32 s52, 1
    s_cselect_b32 s60, 0x200, s94
    s_min_i32 s53, s53, 0x2000
    s_max_i32 s53, s53, 0
    s_add_u32 s94, s53, 15
    s_lshr_b32 s94, s94, 4
    s_cmp_lt_i32 s53, 1
    s_cselect_b32 s61, 0x200, s94
    s_min_i32 s54, s54, 0x2000
    s_max_i32 s54, s54, 0
    s_add_u32 s94, s54, 15
    s_lshr_b32 s94, s94, 4
    s_cmp_lt_i32 s54, 1
    s_cselect_b32 s62, 0x200, s94
    s_min_i32 s55, s55, 0x2000
    s_max_i32 s55, s55, 0
    s_add_u32 s94, s55, 15
    s_lshr_b32 s94, s94, 4
    s_cmp_lt_i32 s55, 1
    s_cselect_b32 s63, 0x200, s94
    s_max_u32 s98, s56, s57
    s_min_i32 s91, s48, s49
    s_max_u32 s98, s98, s58
    s_min_i32 s91, s91, s50
    s_max_u32 s98, s98, s59
    s_min_i32 s91, s91, s51
    s_max_u32 s98, s98, s60
    s_min_i32 s91, s91, s52
    s_max_u32 s98, s98, s61
    s_min_i32 s91, s91, s53
    s_max_u32 s98, s98, s62
    s_min_i32 s91, s91, s54
    s_max_u32 s98, s98, s63
    s_min_i32 s91, s91, s55
    s_waitcnt vmcnt(0)
    v_min3_u32 v112, v96, v97, v98
    v_max3_u32 v113, v96, v97, v98
    v_min3_u32 v112, v112, v99, v100
    v_max3_u32 v113, v113, v99, v100
    v_min3_u32 v112, v112, v101, v102
    v_max3_u32 v113, v113, v101, v102
    v_min_u32 v112, v112, v103
    v_max_u32 v113, v113, v103
    v_cmp_ne_u32 vcc, v112, v113
    v_perm_b32 v116, v97, v96, s4
    v_perm_b32 v117, v99, v98, s4
    v_perm_b32 v118, v101, v100, s4
    v_perm_b32 v119, v103, v102, s4
    ds_write_b128 v23, v[116:119] offset:0
    s_ff1_i32_b64 s94, vcc
    s_lshl_b32 s95, s73, 6
    s_add_u32 s95, s95, s94
    s_cmp_lt_i32 s94, 0
    s_cselect_b32 s95, 0x200, s95
    v_mov_b32 v114, s95
    s_mov_b64 exec, 1
    ds_write_b32 v25, v114
    s_mov_b64 exec, -1
    s_waitcnt lgkmcnt(0)
    s_barrier
    ds_read_b128 v[116:119], v26
    ds_read_b128 v[120:123], v26 offset:16
    s_waitcnt lgkmcnt(0)
    v_min3_u32 v112, v116, v117, v118
    v_min3_u32 v113, v119, v120, v121
    v_min3_u32 v112, v112, v122, v123
    v_min_u32 v112, v112, v113
    s_nop 0
    v_readfirstlane_b32 s79, v112
    s_nop 0
    s_min_u32 s79, s79, s98
    s_cmp_lt_u32 s79, 8
    s_cselect_b32 s79, 0, s79
    s_mov_b32 s64, 0
    s_sub_i32 s56, s56, s79
    s_max_i32 s56, s56, 0
    s_add_u32 s65, s64, s56
    s_sub_i32 s57, s57, s79
    s_max_i32 s57, s57, 0
    s_add_u32 s66, s65, s57
    s_sub_i32 s58, s58, s79
    s_max_i32 s58, s58, 0
    s_add_u32 s67, s66, s58
    s_sub_i32 s59, s59, s79
    s_max_i32 s59, s59, 0
    s_add_u32 s68, s67, s59
    s_sub_i32 s60, s60, s79
    s_max_i32 s60, s60, 0
    s_add_u32 s69, s68, s60
    s_sub_i32 s61, s61, s79
    s_max_i32 s61, s61, 0
    s_add_u32 s70, s69, s61
    s_sub_i32 s62, s62, s79
    s_max_i32 s62, s62, 0
    s_add_u32 s71, s70, s62
    s_sub_i32 s63, s63, s79
    s_max_i32 s63, s63, 0
    s_add_u32 s72, s71, s63
    s_mul_i32 s94, s79, 13
    s_lshr_b32 s94, s94, 3
    s_add_u32 s95, s94, s72
    s_cmp_le_u32 s95, 0
    s_cselect_b32 s0, 56, 64
    s_mul_i32 s94, s94, s0
    v_cvt_f32_u32 v112, s94
    v_cvt_f32_u32 v113, s95
    v_rcp_f32 v113, v113
    s_nop 0
    v_mul_f32 v112, v112, v113
    v_add_f32 v112, 0.5, v112
    v_cvt_u32_f32 v112, v112
    s_nop 0
    v_readfirstlane_b32 s80, v112
    s_min_u32 s95, s72, 1
    s_sub_u32 s95, s0, s95
    s_add_u32 s94, s79, 63
    s_lshr_b32 s94, s94, 6
    s_max_u32 s80, s80, s94
    s_min_u32 s80, s80, s95
    s_min_u32 s80, s80, s79
    s_sub_u32 s81, s0, s80
    s_min_u32 s81, s81, s72
    s_sub_i32 s90, s75, s80
    s_cmp_ge_i32 s90, s81
    s_cbranch_scc1 L_fonly
    s_cmp_lt_u32 s75, s80
    s_cselect_b32 s94, s79, s72
    s_cselect_b32 s95, s75, s90
    s_cselect_b32 s96, s80, s81
    s_mul_i32 s95, s95, s94
    s_add_u32 s94, s94, s95
    v_cvt_f32_u32 v112, s96
    v_cvt_f32_u32 v113, s95
    v_rcp_f32 v112, v112
    v_cvt_f32_u32 v114, s94
    v_add_f32 v113, 0.5, v113
    v_add_f32 v114, 0.5, v114
    v_mul_f32 v113, v113, v112
    v_mul_f32 v114, v114, v112
    v_cvt_u32_f32 v113, v113
    v_cvt_u32_f32 v114, v114
    v_readfirstlane_b32 s83, v113
    v_readfirstlane_b32 s84, v114
    s_nop 0
    v_add_u32 v112, s83, v1
    s_sub_u32 s85, s84, s83
    v_mov_b32 v113, 0x0
    s_cmp_lt_u32 s75, s80
    s_cbranch_scc1 L_list
    s_sub_i32 s95, s79, s64
    s_lshl_b32 s95, s95, 4
    s_add_u32 s96, s95, 0x0
    s_sub_i32 s95, s48, s95
    v_mov_b32 v113, s96
    v_mov_b32 v11, s95
    v_mov_b32 v12, 0
    s_sub_i32 s95, s79, s65
    s_lshl_b32 s95, s95, 4
    s_add_u32 s96, s95, 0x2
    s_sub_i32 s95, s49, s95
    v_cmpx_le_u32 vcc, s65, v112
    v_mov_b32 v113, s96
    v_mov_b32 v11, s95
    v_mov_b32 v12, 1
    s_sub_i32 s95, s79, s66
    s_lshl_b32 s95, s95, 4
    s_add_u32 s96, s95, 0x4
    s_sub_i32 s95, s50, s95
    v_cmpx_le_u32 vcc, s66, v112
    v_mov_b32 v113, s96
    v_mov_b32 v11, s95
    v_mov_b32 v12, 2
    s_sub_i32 s95, s79, s67
    s_lshl_b32 s95, s95, 4
    s_add_u32 s96, s95, 0x6
    s_sub_i32 s95, s51, s95
    v_cmpx_le_u32 vcc, s67, v112
    v_mov_b32 v113, s96
    v_mov_b32 v11, s95
    v_mov_b32 v12, 3
    s_sub_i32 s95, s79, s68
    s_lshl_b32 s95, s95, 4
    s_add_u32 s96, s95, 0x8
    s_sub_i32 s95, s52, s95
    v_cmpx_le_u32 vcc, s68, v112
    v_mov_b32 v113, s96
    v_mov_b32 v11, s95
    v_mov_b32 v12, 4
    s_sub_i32 s95, s79, s69
    s_lshl_b32 s95, s95, 4
    s_add_u32 s96, s95, 0xa
    s_sub_i32 s95, s53, s95
    v_cmpx_le_u32 vcc, s69, v112
    v_mov_b32 v113, s96
    v_mov_b32 v11, s95
    v_mov_b32 v12, 5
    s_sub_i32 s95, s79, s70
    s_lshl_b32 s95, s95, 4
    s_add_u32 s96, s95, 0xc
    s_sub_i32 s95, s54, s95
    v_cmpx_le_u32 vcc, s70, v112
    v_mov_b32 v113, s96
    v_mov_b32 v11, s95
    v_mov_b32 v12, 6
    s_sub_i32 s95, s79, s71
    s_lshl_b32 s95, s95, 4
    s_add_u32 s96, s95, 0xe
    s_sub_i32 s95, s55, s95
    v_cmpx_le_u32 vcc, s71, v112
    v_mov_b32 v113, s96
    v_mov_b32 v11, s95
    v_mov_b32 v12, 7
    s_mov_b64 exec, -1
    v_lshlrev_b32 v114, 4, v112
    v_sub_u32 v11, v11, v114
    s_nop 1
L_list:
    v_lshl_add_u32 v113, v112, 4, v113
    ds_read_u16 v114, v113
    v_cmp_gt_u32 vcc, s84, v112
    v_mov_b32 v115, 0x40000000
    s_waitcnt lgkmcnt(0)
    v_lshlrev_b32 v114, 15, v114
    v_cndmask_b32 v10, v115, v114, vcc
    v_readlane_b32 s87, v12, s77
    v_readlane_b32 s7, v10, s77
    s_cmp_lt_u32 s75, s80
    s_nop 2
    s_cbranch_scc1 L_gq
    buffer_load_dwordx4 v[64:67], v2, s[20:23], s7 offen offset:0 nt
    buffer_load_dwordx4 v[68:71], v2, s[20:23], s7 offen offset:2048 nt
    buffer_load_dwordx4 v[72:75], v3, s[20:23], s7 offen offset:0 nt
    buffer_load_dwordx4 v[76:79], v3, s[20:23], s7 offen offset:2048 nt
    s_branch L_gq2
L_gq:
    s_lshl_b32 s94, s74, 11
    s_lshl_b32 s95, s76, 10
    s_add_u32 s94, s94, s95
    v_lshl_add_u32 v6, v1, 4, s94
    s_lshl_b32 s95, s77, 14
    s_add_u32 s96, s95, 0x2000
    buffer_load_dwordx4 v[128:131], v6, s[28:31], s95 offen
    buffer_load_dwordx4 v[132:135], v6, s[28:31], s96 offen
L_gq2:
    s_cmp_lt_u32 s75, s80
    s_cbranch_scc1 L_fl_12s
    s_lshl_b32 s94, s74, 11
    s_lshl_b32 s95, s76, 10
    s_add_u32 s94, s94, s95
    v_lshl_add_u32 v6, v229, 8, s94
    v_lshl_add_u32 v6, v227, 6, v6
    v_lshl_add_u32 v6, v228, 4, v6
    s_lshl_b32 s94, s87, 13
    buffer_load_dwordx4 v[28:31], v6, s[28:31], s94 offen
    buffer_load_dwordx4 v[80:83], v4, s[24:27], s7 offen offset:0 nt
    buffer_load_dwordx4 v[84:87], v4, s[24:27], s7 offen offset:2048 nt
    buffer_load_dwordx4 v[88:91], v5, s[24:27], s7 offen offset:0 nt
    buffer_load_dwordx4 v[92:95], v5, s[24:27], s7 offen offset:2048 nt
    s_branch L_fl_12v
L_fl_12s:
    buffer_load_dwordx4 v[64:67], v2, s[20:23], s7 offen offset:0 nt
    buffer_load_dwordx4 v[68:71], v2, s[20:23], s7 offen offset:2048 nt
    buffer_load_dwordx4 v[72:75], v3, s[20:23], s7 offen offset:0 nt
    buffer_load_dwordx4 v[76:79], v3, s[20:23], s7 offen offset:2048 nt
L_fl_12v:
    s_branch L_go
.p2align 4
L_code_end:
.section .rodata,"a"
.p2align 6
.amdhsa_kernel standalone__paged_block_table_kv_radixattention__sampling_kernel
  .amdhsa_next_free_vgpr 248
  .amdhsa_next_free_sgpr 102
  .amdhsa_accum_offset 248
  .amdhsa_group_segment_fixed_size 0
  .amdhsa_kernarg_size 64
  .amdhsa_user_sgpr_count 2
  .amdhsa_user_sgpr_kernarg_segment_ptr 1
  .amdhsa_system_sgpr_workgroup_id_x 1
.end_amdhsa_kernel
```
